```python
import torch

def _softmax(x, axis=-1):
    return torch.softmax(x, dim=axis)
def _gelu(x):
    return torch.nn.functional.gelu(x, approximate="tanh")
def _silu(x):
    return torch.nn.functional.silu(x)
def _sigmoid(x):
    return torch.sigmoid(x)
def _layernorm(x, axis=-1, eps=1e-5):
    m = x.mean(dim=axis, keepdim=True)
    v = x.var(dim=axis, keepdim=True, unbiased=False)
    return (x - m) / torch.sqrt(v + eps)
def _scatter_add(tgt, idx, src, axis=0):
    return tgt.clone().index_add_(axis, idx, src)
def _segment_sum(src, seg, n):
    out = torch.zeros((n,) + src.shape[1:], dtype=src.dtype)
    return out.index_add_(0, seg, src)
def _pad(x, pw):
    flat = tuple(v for pair in reversed(pw) for v in pair)
    return torch.nn.functional.pad(x, flat)

kernel_name = 'sequential_preLN__mha_block__dense_activation_silu__prompt'

def setup_inputs():

    _w = (lambda a: (lambda t: t.to(torch.bfloat16) if t.is_floating_point() else t)(torch.as_tensor(a)))
    def _A_setup():
        B, S, D, H = 1, 2048, 640, 32
        return {
            "x": _w((lambda *s: torch.randn(*s, dtype=torch.bfloat16) * 0.05)(B, S, D)),
            "wqkv": _w((lambda *s: torch.randn(*s, dtype=torch.bfloat16) * 0.05)(D, 3 * D)),
            "wo": _w((lambda *s: torch.randn(*s, dtype=torch.bfloat16) * 0.05)(D, D)),
        }
    _A_in = _A_setup()

    def _B_setup():
        B, S, D, F = 1, 2048, 640, 1728
        return {
            "x": _w((lambda *s: torch.randn(*s, dtype=torch.bfloat16) * 0.05)(B, S, D)),
            "w1": _w((lambda *s: torch.randn(*s, dtype=torch.bfloat16) * 1.6)(D, F) * (D ** -0.5)),
            "w2": _w((lambda *s: torch.randn(*s, dtype=torch.bfloat16) * 0.2)(F, D) * (F ** -0.5)),
        }
    _B_in = _B_setup()

    return {
        "A_x": _A_in["x"],
        "A_wqkv": _A_in["wqkv"],
        "A_wo": _A_in["wo"],
        "B_x": _B_in["x"],
        "B_w1": _B_in["w1"],
        "B_w2": _B_in["w2"],
    }

def reference(A_x, A_wqkv, A_wo, B_x, B_w1, B_w2):
    def _A_ref(x, wqkv, wo):
        B, S, D = x.shape
        H = 32
        Dh = D // H
        qkv = (lambda x, *d: x.permute(*d))((x @ wqkv).reshape(B, S, 3, H, Dh), 2, 0, 3, 1, 4)
        q, k, v = qkv[0], qkv[1], qkv[2]
        scores = torch.einsum("bhqd,bhkd->bhqk", q, k) * (Dh ** -0.5)
        p = _softmax(scores, axis=-1)
        o = torch.einsum("bhqk,bhkd->bhqd", p, v)
        return (lambda x, *d: x.permute(*d))(o, 0, 2, 1, 3).reshape(B, S, D) @ wo

    def _B_ref(x, w1, w2):
        h = torch.einsum("bsd,df->bsf", x, w1)
        h = _silu(h)
        out = torch.einsum("bsf,fd->bsd", h, w2)
        return out

    x = A_x
    h = x + _A_ref(_layernorm(x, axis=-1), A_wqkv, A_wo)
    h2 = h + _B_ref(_layernorm(h, axis=-1), B_w1, B_w2)
    return h2
```

```asm
; @launch grid=(256,1,1) block=(512,1,1) lds=163840
.amdgcn_target "amdgcn-amd-amdhsa--gfx950"
.text
.globl sequential_preLN__mha_block__dense_activation_silu__prompt_kernel
.p2align 8
.type sequential_preLN__mha_block__dense_activation_silu__prompt_kernel,@function
sequential_preLN__mha_block__dense_activation_silu__prompt_kernel:
    s_cmp_ge_u32 s2, 256
    s_cbranch_scc1 L_end
    s_load_dwordx2 s[4:5], s[0:1], 0
    s_load_dwordx2 s[8:9], s[0:1], 8
    s_load_dwordx2 s[20:21], s[0:1], 56
    s_load_dwordx16 s[36:51], s[0:1], 0
    s_load_dwordx2 s[52:53], s[0:1], 64
    s_memrealtime s[32:33]
    v_lshrrev_b32 v1, 6, v0
    v_and_b32 v0, 63, v0
    v_readfirstlane_b32 s28, v1
    s_and_b32 s29, s2, 7
    s_lshr_b32 s30, s2, 3
    s_cmp_lg_u32 s28, 1
    s_cbranch_scc1 L_cpf_1
    s_getpc_b64 s[58:59]
L_pc_here:
    s_mul_i32 s54, s30, 1024
    s_sub_u32 s54, s54, L_pc_here-sequential_preLN__mha_block__dense_activation_silu__prompt_kernel
    v_lshl_add_u32 v3, v0, 7, s54
    v_ashrrev_i32 v5, 31, v3
    v_mov_b32 v6, s59
    v_add_co_u32 v4, vcc, s58, v3
    s_mov_b64 exec, 255
    s_nop 0
    v_addc_co_u32 v5, vcc, v5, v6, vcc
    global_load_dword v254, v[4:5], off
    s_mov_b64 exec, -1
L_cpf_1:
    s_lshr_b32 s54, s29, 1
    s_lshl_b32 s54, s54, 2
    s_lshr_b32 s55, s30, 3
    s_add_u32 s64, s54, s55
    s_and_b32 s54, s29, 1
    s_lshl_b32 s54, s54, 3
    s_and_b32 s56, s30, 7
    s_add_u32 s65, s54, s56
    s_add_u32 s55, s55, s56
    s_lshr_b32 s54, s29, 1
    s_lshl_b32 s55, s55, 2
    s_mov_b32 s58, 0x00000000
    s_mov_b32 s59, 0x00000000
    s_lshr_b64 s[58:59], s[58:59], s55
    s_and_b32 s66, s58, 15
    s_lshl_b32 s54, s54, 2
    s_lshr_b32 s54, 0x8630, s54
    s_and_b32 s54, s54, 15
    s_add_u32 s66, s66, s54
    s_mul_i32 s54, s66, 26
    s_lshr_b32 s54, s54, 8
    s_mul_i32 s54, s54, 10
    s_sub_u32 s66, s66, s54
    s_mov_b32 s82, s66
    s_mul_i32 s71, s64, 163840
    s_lshl_b32 s54, s66, 7
    s_add_u32 s67, s71, s54
    s_mul_i32 s68, s66, 245760
    s_lshl_b32 s69, s65, 8
    s_add_u32 s68, s68, s69
    s_lshl_b32 s80, s28, 11
    s_sub_u32 s66, 9, s66
    v_lshrrev_b32 v1, 3, v0
    v_lshrrev_b32 v2, 4, v0
    v_and_b32 v3, 7, v0
    v_xor_b32 v3, v3, v2
    s_lshl_b32 s54, s28, 4
    v_add_u32 v4, s54, v1
    v_mul_u32_u24 v4, 1280, v4
    v_lshl_add_u32 v78, v3, 4, v4
    v_xor_b32 v79, 64, v78
    v_add_u32 v79, 10240, v79
    v_lshlrev_b32 v3, 2, v2
    v_and_b32 v4, 15, v0
    v_xor_b32 v3, v3, v4
    s_lshl_b32 s54, s28, 3
    v_add_u32 v4, s54, v2
    v_mul_u32_u24 v4, 3840, v4
    v_lshl_add_u32 v80, v3, 4, v4
    s_mov_b32 s6, 2621440
    s_mov_b32 s7, 0x20000
    s_mov_b32 s10, 2457600
    s_mov_b32 s11, 0x20000
    s_mov_b32 s22, 256
    s_mov_b32 s23, 0x20000
    s_waitcnt lgkmcnt(0)
    s_or_b32 s54, s2, s28
    s_cbranch_scc0 L_nonce_pub
L_nonce_done:
    s_cmp_eq_u32 s65, 15
    s_cbranch_scc1 L_p1_noissue
    s_mov_b32 m0, s80
    s_add_u32 s80, s80, 32768
    buffer_load_dwordx4 v78, s[4:7], s67 offen lds
    s_add_u32 m0, m0, 16384
    s_add_u32 s81, s68, 15360
    buffer_load_dwordx4 v80, s[8:11], s68 offen lds
    s_sub_u32 m0, m0, 15360
    s_add_u32 s68, s68, 245760
    buffer_load_dwordx4 v79, s[4:7], s67 offen lds
    s_add_u32 m0, m0, 16384
    s_add_u32 s67, s67, 128
    buffer_load_dwordx4 v80, s[8:11], s81 offen lds
    s_and_b32 s80, s80, 0x1ffff
    s_sub_u32 s66, s66, 1
    s_cmov_b32 s67, s71
    s_cmov_b32 s68, s69
L_p1_noissue:
    s_mov_b32 s12, s52
    s_and_b32 s13, s53, 0xffff
    s_mov_b32 s14, 31457280
    s_mov_b32 s15, 0x20000
    s_mov_b32 s16, s48
    s_and_b32 s17, s49, 0xffff
    s_mov_b32 s18, 2621440
    s_mov_b32 s19, 0x20000
    s_mov_b64 s[24:25], 0
    s_mov_b32 s26, 0
    s_mov_b32 s27, 0x20000
    v_mov_b32 v157, 0
    s_cmp_eq_u32 s65, 15
    s_cbranch_scc0 L_p1_go
    v_lshrrev_b32 v1, 3, v0
    s_lshl_b32 s54, s28, 4
    s_lshl_b32 s55, s64, 7
    s_add_u32 s54, s54, s55
    v_add_u32 v1, s54, v1
    v_mul_u32_u24 v2, 1280, v1
    v_and_b32 v3, 7, v0
    v_lshl_add_u32 v2, v3, 4, v2
    s_mov_b32 s54, 10240
    buffer_load_dwordx4 v[100:103], v2, s[4:7], 0 offen offset:0
    buffer_load_dwordx4 v[104:107], v2, s[4:7], s54 offen offset:0
    buffer_load_dwordx4 v[108:111], v2, s[4:7], 0 offen offset:128
    buffer_load_dwordx4 v[112:115], v2, s[4:7], s54 offen offset:128
    buffer_load_dwordx4 v[116:119], v2, s[4:7], 0 offen offset:256
    buffer_load_dwordx4 v[120:123], v2, s[4:7], s54 offen offset:256
    buffer_load_dwordx4 v[124:127], v2, s[4:7], 0 offen offset:384
    buffer_load_dwordx4 v[128:131], v2, s[4:7], s54 offen offset:384
    buffer_load_dwordx4 v[132:135], v2, s[4:7], 0 offen offset:512
    buffer_load_dwordx4 v[136:139], v2, s[4:7], s54 offen offset:512
    buffer_load_dwordx4 v[140:143], v2, s[4:7], 0 offen offset:640
    buffer_load_dwordx4 v[144:147], v2, s[4:7], s54 offen offset:640
    buffer_load_dwordx4 v[148:151], v2, s[4:7], 0 offen offset:768
    buffer_load_dwordx4 v[152:155], v2, s[4:7], s54 offen offset:768
    buffer_load_dwordx4 v[156:159], v2, s[4:7], 0 offen offset:896
    buffer_load_dwordx4 v[160:163], v2, s[4:7], s54 offen offset:896
    buffer_load_dwordx4 v[164:167], v2, s[4:7], 0 offen offset:1024
    buffer_load_dwordx4 v[168:171], v2, s[4:7], s54 offen offset:1024
    buffer_load_dwordx4 v[172:175], v2, s[4:7], 0 offen offset:1152
    buffer_load_dwordx4 v[176:179], v2, s[4:7], s54 offen offset:1152
    v_mov_b32 v4, 0
    v_mov_b32 v5, 0
    v_mov_b32 v6, 0
    v_mov_b32 v7, 0
    v_mov_b32 v8, 0x3f803f80
    s_waitcnt vmcnt(18)
    v_dot2_f32_bf16 v4, v100, v8, v4
    v_dot2_f32_bf16 v6, v100, v100, v6
    v_dot2_f32_bf16 v5, v104, v8, v5
    v_dot2_f32_bf16 v7, v104, v104, v7
    v_dot2_f32_bf16 v4, v101, v8, v4
    v_dot2_f32_bf16 v6, v101, v101, v6
    v_dot2_f32_bf16 v5, v105, v8, v5
    v_dot2_f32_bf16 v7, v105, v105, v7
    v_dot2_f32_bf16 v4, v102, v8, v4
    v_dot2_f32_bf16 v6, v102, v102, v6
    v_dot2_f32_bf16 v5, v106, v8, v5
    v_dot2_f32_bf16 v7, v106, v106, v7
    v_dot2_f32_bf16 v4, v103, v8, v4
    v_dot2_f32_bf16 v6, v103, v103, v6
    v_dot2_f32_bf16 v5, v107, v8, v5
    v_dot2_f32_bf16 v7, v107, v107, v7
    s_waitcnt vmcnt(16)
    v_dot2_f32_bf16 v4, v108, v8, v4
    v_dot2_f32_bf16 v6, v108, v108, v6
    v_dot2_f32_bf16 v5, v112, v8, v5
    v_dot2_f32_bf16 v7, v112, v112, v7
    v_dot2_f32_bf16 v4, v109, v8, v4
    v_dot2_f32_bf16 v6, v109, v109, v6
    v_dot2_f32_bf16 v5, v113, v8, v5
    v_dot2_f32_bf16 v7, v113, v113, v7
    v_dot2_f32_bf16 v4, v110, v8, v4
    v_dot2_f32_bf16 v6, v110, v110, v6
    v_dot2_f32_bf16 v5, v114, v8, v5
    v_dot2_f32_bf16 v7, v114, v114, v7
    v_dot2_f32_bf16 v4, v111, v8, v4
    v_dot2_f32_bf16 v6, v111, v111, v6
    v_dot2_f32_bf16 v5, v115, v8, v5
    v_dot2_f32_bf16 v7, v115, v115, v7
    s_waitcnt vmcnt(14)
    v_dot2_f32_bf16 v4, v116, v8, v4
    v_dot2_f32_bf16 v6, v116, v116, v6
    v_dot2_f32_bf16 v5, v120, v8, v5
    v_dot2_f32_bf16 v7, v120, v120, v7
    v_dot2_f32_bf16 v4, v117, v8, v4
    v_dot2_f32_bf16 v6, v117, v117, v6
    v_dot2_f32_bf16 v5, v121, v8, v5
    v_dot2_f32_bf16 v7, v121, v121, v7
    v_dot2_f32_bf16 v4, v118, v8, v4
    v_dot2_f32_bf16 v6, v118, v118, v6
    v_dot2_f32_bf16 v5, v122, v8, v5
    v_dot2_f32_bf16 v7, v122, v122, v7
    v_dot2_f32_bf16 v4, v119, v8, v4
    v_dot2_f32_bf16 v6, v119, v119, v6
    v_dot2_f32_bf16 v5, v123, v8, v5
    v_dot2_f32_bf16 v7, v123, v123, v7
    s_waitcnt vmcnt(12)
    v_dot2_f32_bf16 v4, v124, v8, v4
    v_dot2_f32_bf16 v6, v124, v124, v6
    v_dot2_f32_bf16 v5, v128, v8, v5
    v_dot2_f32_bf16 v7, v128, v128, v7
    v_dot2_f32_bf16 v4, v125, v8, v4
    v_dot2_f32_bf16 v6, v125, v125, v6
    v_dot2_f32_bf16 v5, v129, v8, v5
    v_dot2_f32_bf16 v7, v129, v129, v7
    v_dot2_f32_bf16 v4, v126, v8, v4
    v_dot2_f32_bf16 v6, v126, v126, v6
    v_dot2_f32_bf16 v5, v130, v8, v5
    v_dot2_f32_bf16 v7, v130, v130, v7
    v_dot2_f32_bf16 v4, v127, v8, v4
    v_dot2_f32_bf16 v6, v127, v127, v6
    v_dot2_f32_bf16 v5, v131, v8, v5
    v_dot2_f32_bf16 v7, v131, v131, v7
    s_waitcnt vmcnt(10)
    v_dot2_f32_bf16 v4, v132, v8, v4
    v_dot2_f32_bf16 v6, v132, v132, v6
    v_dot2_f32_bf16 v5, v136, v8, v5
    v_dot2_f32_bf16 v7, v136, v136, v7
    v_dot2_f32_bf16 v4, v133, v8, v4
    v_dot2_f32_bf16 v6, v133, v133, v6
    v_dot2_f32_bf16 v5, v137, v8, v5
    v_dot2_f32_bf16 v7, v137, v137, v7
    v_dot2_f32_bf16 v4, v134, v8, v4
    v_dot2_f32_bf16 v6, v134, v134, v6
    v_dot2_f32_bf16 v5, v138, v8, v5
    v_dot2_f32_bf16 v7, v138, v138, v7
    v_dot2_f32_bf16 v4, v135, v8, v4
    v_dot2_f32_bf16 v6, v135, v135, v6
    v_dot2_f32_bf16 v5, v139, v8, v5
    v_dot2_f32_bf16 v7, v139, v139, v7
    s_waitcnt vmcnt(8)
    v_dot2_f32_bf16 v4, v140, v8, v4
    v_dot2_f32_bf16 v6, v140, v140, v6
    v_dot2_f32_bf16 v5, v144, v8, v5
    v_dot2_f32_bf16 v7, v144, v144, v7
    v_dot2_f32_bf16 v4, v141, v8, v4
    v_dot2_f32_bf16 v6, v141, v141, v6
    v_dot2_f32_bf16 v5, v145, v8, v5
    v_dot2_f32_bf16 v7, v145, v145, v7
    v_dot2_f32_bf16 v4, v142, v8, v4
    v_dot2_f32_bf16 v6, v142, v142, v6
    v_dot2_f32_bf16 v5, v146, v8, v5
    v_dot2_f32_bf16 v7, v146, v146, v7
    v_dot2_f32_bf16 v4, v143, v8, v4
    v_dot2_f32_bf16 v6, v143, v143, v6
    v_dot2_f32_bf16 v5, v147, v8, v5
    v_dot2_f32_bf16 v7, v147, v147, v7
    s_waitcnt vmcnt(6)
    v_dot2_f32_bf16 v4, v148, v8, v4
    v_dot2_f32_bf16 v6, v148, v148, v6
    v_dot2_f32_bf16 v5, v152, v8, v5
    v_dot2_f32_bf16 v7, v152, v152, v7
    v_dot2_f32_bf16 v4, v149, v8, v4
    v_dot2_f32_bf16 v6, v149, v149, v6
    v_dot2_f32_bf16 v5, v153, v8, v5
    v_dot2_f32_bf16 v7, v153, v153, v7
    v_dot2_f32_bf16 v4, v150, v8, v4
    v_dot2_f32_bf16 v6, v150, v150, v6
    v_dot2_f32_bf16 v5, v154, v8, v5
    v_dot2_f32_bf16 v7, v154, v154, v7
    v_dot2_f32_bf16 v4, v151, v8, v4
    v_dot2_f32_bf16 v6, v151, v151, v6
    v_dot2_f32_bf16 v5, v155, v8, v5
    v_dot2_f32_bf16 v7, v155, v155, v7
    s_waitcnt vmcnt(4)
    v_dot2_f32_bf16 v4, v156, v8, v4
    v_dot2_f32_bf16 v6, v156, v156, v6
    v_dot2_f32_bf16 v5, v160, v8, v5
    v_dot2_f32_bf16 v7, v160, v160, v7
    v_dot2_f32_bf16 v4, v157, v8, v4
    v_dot2_f32_bf16 v6, v157, v157, v6
    v_dot2_f32_bf16 v5, v161, v8, v5
    v_dot2_f32_bf16 v7, v161, v161, v7
    v_dot2_f32_bf16 v4, v158, v8, v4
    v_dot2_f32_bf16 v6, v158, v158, v6
    v_dot2_f32_bf16 v5, v162, v8, v5
    v_dot2_f32_bf16 v7, v162, v162, v7
    v_dot2_f32_bf16 v4, v159, v8, v4
    v_dot2_f32_bf16 v6, v159, v159, v6
    v_dot2_f32_bf16 v5, v163, v8, v5
    v_dot2_f32_bf16 v7, v163, v163, v7
    s_waitcnt vmcnt(2)
    v_mov_b32 v3, 0
    buffer_load_dwordx2 v[92:93], v3, s[20:23], 0 offen sc1
    v_dot2_f32_bf16 v4, v164, v8, v4
    v_dot2_f32_bf16 v6, v164, v164, v6
    v_dot2_f32_bf16 v5, v168, v8, v5
    v_dot2_f32_bf16 v7, v168, v168, v7
    v_dot2_f32_bf16 v4, v165, v8, v4
    v_dot2_f32_bf16 v6, v165, v165, v6
    v_dot2_f32_bf16 v5, v169, v8, v5
    v_dot2_f32_bf16 v7, v169, v169, v7
    v_dot2_f32_bf16 v4, v166, v8, v4
    v_dot2_f32_bf16 v6, v166, v166, v6
    v_dot2_f32_bf16 v5, v170, v8, v5
    v_dot2_f32_bf16 v7, v170, v170, v7
    v_dot2_f32_bf16 v4, v167, v8, v4
    v_dot2_f32_bf16 v6, v167, v167, v6
    v_dot2_f32_bf16 v5, v171, v8, v5
    v_dot2_f32_bf16 v7, v171, v171, v7
    s_waitcnt vmcnt(1)
    v_dot2_f32_bf16 v4, v172, v8, v4
    v_dot2_f32_bf16 v6, v172, v172, v6
    v_dot2_f32_bf16 v5, v176, v8, v5
    v_dot2_f32_bf16 v7, v176, v176, v7
    v_dot2_f32_bf16 v4, v173, v8, v4
    v_dot2_f32_bf16 v6, v173, v173, v6
    v_dot2_f32_bf16 v5, v177, v8, v5
    v_dot2_f32_bf16 v7, v177, v177, v7
    v_dot2_f32_bf16 v4, v174, v8, v4
    v_dot2_f32_bf16 v6, v174, v174, v6
    v_dot2_f32_bf16 v5, v178, v8, v5
    v_dot2_f32_bf16 v7, v178, v178, v7
    v_dot2_f32_bf16 v4, v175, v8, v4
    v_dot2_f32_bf16 v6, v175, v175, v6
    v_dot2_f32_bf16 v5, v179, v8, v5
    v_dot2_f32_bf16 v7, v179, v179, v7
    s_nop 2
    v_add_f32_dpp v4, v4, v4 quad_perm:[1,0,3,2] row_mask:0xf bank_mask:0xf
    v_add_f32_dpp v5, v5, v5 quad_perm:[1,0,3,2] row_mask:0xf bank_mask:0xf
    v_add_f32_dpp v6, v6, v6 quad_perm:[1,0,3,2] row_mask:0xf bank_mask:0xf
    v_add_f32_dpp v7, v7, v7 quad_perm:[1,0,3,2] row_mask:0xf bank_mask:0xf
    v_add_f32_dpp v4, v4, v4 quad_perm:[2,3,0,1] row_mask:0xf bank_mask:0xf
    v_add_f32_dpp v5, v5, v5 quad_perm:[2,3,0,1] row_mask:0xf bank_mask:0xf
    v_add_f32_dpp v6, v6, v6 quad_perm:[2,3,0,1] row_mask:0xf bank_mask:0xf
    v_add_f32_dpp v7, v7, v7 quad_perm:[2,3,0,1] row_mask:0xf bank_mask:0xf
    v_add_f32_dpp v4, v4, v4 row_half_mirror row_mask:0xf bank_mask:0xf
    v_add_f32_dpp v5, v5, v5 row_half_mirror row_mask:0xf bank_mask:0xf
    v_add_f32_dpp v6, v6, v6 row_half_mirror row_mask:0xf bank_mask:0xf
    v_add_f32_dpp v7, v7, v7 row_half_mirror row_mask:0xf bank_mask:0xf
    s_waitcnt vmcnt(0)
    s_mov_b32 s62, 0
L_nchk_2:
    v_readfirstlane_b32 s32, v92
    v_readfirstlane_b32 s33, v93
    s_add_u32 s62, s62, 1
    s_or_b32 s54, s32, s33
    s_cbranch_scc1 L_nok_3
    s_cmp_ge_u32 s62, 200000
    s_cbranch_scc1 L_nok_3
    v_mov_b32 v94, 0
    buffer_load_dwordx2 v[92:93], v94, s[20:23], 0 offen sc1
    s_waitcnt vmcnt(0)
    s_branch L_nchk_2
L_nok_3:
    v_and_b32 v3, 1, v0
    v_cmp_ne_u32 vcc, 0, v3
    v_lshlrev_b32 v3, 3, v3
    v_add_u32 v1, v1, v3
    v_cndmask_b32 v4, v4, v5, vcc
    v_cndmask_b32 v6, v6, v7, vcc
    v_mul_f32 v4, 0x3acccccd, v4
    v_mul_f32 v5, v4, v4
    v_mov_b32 v7, 0x3acccccd
    v_fma_f32 v5, v6, v7, -v5
    v_max_f32 v5, 0, v5
    v_add_f32 v5, 0x3727c5ac, v5
    v_rsq_f32 v8, v5
    v_mov_b32 v9, s32
    v_mov_b32 v11, s32
    v_mul_f32 v10, v4, v8
    v_lshlrev_b32 v1, 4, v1
    s_mov_b32 s54, 30146560
    s_mov_b32 exec_lo, 0x03030303
    s_mov_b32 exec_hi, 0x03030303
    buffer_store_dwordx4 v[8:11], v1, s[12:15], s54 offen sc1
    s_mov_b64 exec, -1
    s_branch L_p1_done
L_nonce_pub:
    v_mov_b32 v3, 0
    v_mov_b32 v4, s32
    v_mov_b32 v5, s33
    s_mov_b64 exec, 1
    buffer_store_dwordx2 v[4:5], v3, s[20:23], 0 offen sc1
    s_mov_b64 exec, -1
    s_branch L_nonce_done
L_p1_go:
    s_cmp_ge_u32 s28, 4
    s_cbranch_scc1 L_p1_c
    v_lshrrev_b32 v4, 5, v0
    v_bfe_u32 v5, v0, 2, 2
    v_lshl_add_u32 v6, v4, 3, v5
    v_lshlrev_b32 v6, 8, v6
    v_bfe_u32 v7, v0, 4, 1
    v_and_b32 v8, 3, v0
    v_lshl_add_u32 v7, v7, 2, v8
    v_lshlrev_b32 v7, 3, v7
    v_lshl_add_u32 v7, v5, 6, v7
    s_lshl_b32 s54, s28, 12
    v_add3_u32 v20, v6, v7, s54
    v_xor_b32 v21, 64, v20
    v_xor_b32 v22, 128, v20
    v_xor_b32 v23, 192, v20
    s_lshl_b32 s54, s28, 9
    s_add_u32 s54, s54, 151552
    v_lshl_add_u32 v24, v0, 2, s54
    v_and_b32 v1, 31, v0
    s_mul_i32 s54, s65, 10240
    s_lshl_b32 s55, s28, 8
    s_add_u32 s54, s54, s55
    s_add_u32 s54, s54, 30212096
    v_lshl_add_u32 v25, v1, 3, s54
    v_lshl_add_u32 v25, v4, 10, v25
    s_lshl_b32 s54, s64, 2
    s_add_u32 s54, s54, s28
    s_lshl_b32 s54, s54, 9
    s_add_u32 s54, s54, 30146560
    v_lshl_add_u32 v26, v1, 4, s54
    s_lshl_b32 s54, s28, 7
    v_lshl_add_u32 v27, v1, 2, s54
    v_mov_b32 v28, 0x3f803f80
    s_mov_b32 m0, s80
    s_add_u32 s54, s67, 81920
    buffer_load_dwordx4 v78, s[4:7], s67 offen lds
    s_add_u32 m0, m0, 8192
    s_add_u32 s55, s68, 122880
    buffer_load_dwordx4 v78, s[4:7], s54 offen lds
    s_add_u32 m0, m0, 8192
    s_add_u32 s80, s80, 32768
    buffer_load_dwordx4 v80, s[8:11], s68 offen lds
    s_add_u32 m0, m0, 8192
    s_add_u32 s68, s68, 15360
    buffer_load_dwordx4 v80, s[8:11], s55 offen lds
    s_sub_u32 m0, m0, 23552
    s_add_u32 s55, s55, 15360
    buffer_load_dwordx4 v79, s[4:7], s67 offen lds
    s_add_u32 m0, m0, 8192
    s_add_u32 s67, s67, 128
    buffer_load_dwordx4 v79, s[4:7], s54 offen lds
    s_add_u32 m0, m0, 8192
    s_and_b32 s80, s80, 0x1ffff
    buffer_load_dwordx4 v80, s[8:11], s68 offen lds
    s_add_u32 m0, m0, 8192
    s_add_u32 s68, s68, 230400
    buffer_load_dwordx4 v80, s[8:11], s55 offen lds
    s_sub_u32 s66, s66, 1
    s_cmov_b32 s67, s71
    s_cmov_b32 s68, s69
    s_waitcnt vmcnt(8)
    s_barrier
    s_mov_b32 m0, s80
    s_add_u32 s54, s67, 81920
    buffer_load_dwordx4 v78, s[4:7], s67 offen lds
    s_add_u32 m0, m0, 8192
    s_add_u32 s55, s68, 122880
    buffer_load_dwordx4 v78, s[4:7], s54 offen lds
    s_add_u32 m0, m0, 8192
    s_add_u32 s80, s80, 32768
    buffer_load_dwordx4 v80, s[8:11], s68 offen lds
    s_add_u32 m0, m0, 8192
    s_add_u32 s68, s68, 15360
    buffer_load_dwordx4 v80, s[8:11], s55 offen lds
    s_sub_u32 m0, m0, 23552
    s_add_u32 s55, s55, 15360
    buffer_load_dwordx4 v79, s[4:7], s67 offen lds
    s_add_u32 m0, m0, 8192
    s_add_u32 s67, s67, 128
    buffer_load_dwordx4 v79, s[4:7], s54 offen lds
    s_add_u32 m0, m0, 8192
    s_and_b32 s80, s80, 0x1ffff
    buffer_load_dwordx4 v80, s[8:11], s68 offen lds
    s_add_u32 m0, m0, 8192
    s_add_u32 s68, s68, 230400
    buffer_load_dwordx4 v80, s[8:11], s55 offen lds
    s_sub_u32 s66, s66, 1
    s_cmov_b32 s67, s71
    s_cmov_b32 s68, s69
    v_mov_b32 v29, 0
    buffer_load_dwordx2 v[92:93], v29, s[20:23], 0 offen sc1
    v_mov_b32 v30, 0
    ds_read_b64_tr_b16 v[36:37], v20 offset:16384
    ds_read_b64_tr_b16 v[38:39], v20 offset:17408
    v_mov_b32 v31, 0
    ds_read_b64_tr_b16 v[40:41], v21 offset:16384
    ds_read_b64_tr_b16 v[42:43], v21 offset:17408
    v_mov_b32 v32, 0
    ds_read_b64_tr_b16 v[44:45], v22 offset:16384
    ds_read_b64_tr_b16 v[46:47], v22 offset:17408
    v_mov_b32 v33, 0
    ds_read_b64_tr_b16 v[48:49], v23 offset:16384
    ds_read_b64_tr_b16 v[50:51], v23 offset:17408
    s_waitcnt lgkmcnt(0)
    v_dot2_f32_bf16 v30, v36, v28, v30
    v_dot2_f32_bf16 v31, v40, v28, v31
    v_dot2_f32_bf16 v32, v44, v28, v32
    v_dot2_f32_bf16 v33, v48, v28, v33
    v_dot2_f32_bf16 v30, v37, v28, v30
    v_dot2_f32_bf16 v31, v41, v28, v31
    v_dot2_f32_bf16 v32, v45, v28, v32
    v_dot2_f32_bf16 v33, v49, v28, v33
    v_dot2_f32_bf16 v30, v38, v28, v30
    v_dot2_f32_bf16 v31, v42, v28, v31
    v_dot2_f32_bf16 v32, v46, v28, v32
    v_dot2_f32_bf16 v33, v50, v28, v33
    v_dot2_f32_bf16 v30, v39, v28, v30
    v_dot2_f32_bf16 v31, v43, v28, v31
    v_dot2_f32_bf16 v32, v47, v28, v32
    v_dot2_f32_bf16 v33, v51, v28, v33
    s_nop 2
    v_permlane32_swap_b32 v30, v31
    v_permlane32_swap_b32 v32, v33
    s_nop 0
    v_add_f32 v30, v30, v31
    v_add_f32 v32, v32, v33
    ds_write_b32 v24, v30 offset:0
    ds_write_b32 v24, v32 offset:256
    s_waitcnt vmcnt(9) lgkmcnt(0)
    s_barrier
    s_mov_b32 m0, s80
    s_add_u32 s54, s67, 81920
    buffer_load_dwordx4 v78, s[4:7], s67 offen lds
    s_add_u32 m0, m0, 8192
    s_add_u32 s55, s68, 122880
    buffer_load_dwordx4 v78, s[4:7], s54 offen lds
    s_add_u32 m0, m0, 8192
    s_add_u32 s80, s80, 32768
    buffer_load_dwordx4 v80, s[8:11], s68 offen lds
    s_add_u32 m0, m0, 8192
    s_add_u32 s68, s68, 15360
    buffer_load_dwordx4 v80, s[8:11], s55 offen lds
    s_sub_u32 m0, m0, 23552
    s_add_u32 s55, s55, 15360
    buffer_load_dwordx4 v79, s[4:7], s67 offen lds
    s_add_u32 m0, m0, 8192
    s_add_u32 s67, s67, 128
    buffer_load_dwordx4 v79, s[4:7], s54 offen lds
    s_add_u32 m0, m0, 8192
    s_and_b32 s80, s80, 0x1ffff
    buffer_load_dwordx4 v80, s[8:11], s68 offen lds
    s_add_u32 m0, m0, 8192
    s_add_u32 s68, s68, 230400
    buffer_load_dwordx4 v80, s[8:11], s55 offen lds
    s_sub_u32 s66, s66, 1
    s_cmov_b32 s67, s71
    s_cmov_b32 s68, s69
    v_mov_b32 v30, 0
    ds_read_b64_tr_b16 v[36:37], v20 offset:49152
    ds_read_b64_tr_b16 v[38:39], v20 offset:50176
    v_mov_b32 v31, 0
    ds_read_b64_tr_b16 v[40:41], v21 offset:49152
    ds_read_b64_tr_b16 v[42:43], v21 offset:50176
    v_mov_b32 v32, 0
    ds_read_b64_tr_b16 v[44:45], v22 offset:49152
    ds_read_b64_tr_b16 v[46:47], v22 offset:50176
    v_mov_b32 v33, 0
    ds_read_b64_tr_b16 v[48:49], v23 offset:49152
    ds_read_b64_tr_b16 v[50:51], v23 offset:50176
    v_add_u32 v20, 0x10000, v20
    v_add_u32 v21, 0x10000, v21
    v_add_u32 v22, 0x10000, v22
    v_add_u32 v23, 0x10000, v23
    s_waitcnt lgkmcnt(0)
    v_dot2_f32_bf16 v30, v36, v28, v30
    v_dot2_f32_bf16 v31, v40, v28, v31
    v_dot2_f32_bf16 v32, v44, v28, v32
    v_dot2_f32_bf16 v33, v48, v28, v33
    v_dot2_f32_bf16 v30, v37, v28, v30
    v_dot2_f32_bf16 v31, v41, v28, v31
    v_dot2_f32_bf16 v32, v45, v28, v32
    v_dot2_f32_bf16 v33, v49, v28, v33
    v_dot2_f32_bf16 v30, v38, v28, v30
    v_dot2_f32_bf16 v31, v42, v28, v31
    v_dot2_f32_bf16 v32, v46, v28, v32
    v_dot2_f32_bf16 v33, v50, v28, v33
    v_dot2_f32_bf16 v30, v39, v28, v30
    v_dot2_f32_bf16 v31, v43, v28, v31
    v_dot2_f32_bf16 v32, v47, v28, v32
    v_dot2_f32_bf16 v33, v51, v28, v33
    s_nop 2
    v_permlane32_swap_b32 v30, v31
    v_permlane32_swap_b32 v32, v33
    s_nop 0
    v_add_f32 v30, v30, v31
    v_add_f32 v32, v32, v33
    ds_write_b32 v24, v30 offset:6144
    ds_write_b32 v24, v32 offset:6400
    s_waitcnt vmcnt(8)
    s_mov_b32 s62, 0
L_nchk_4:
    v_readfirstlane_b32 s32, v92
    v_readfirstlane_b32 s33, v93
    s_add_u32 s62, s62, 1
    s_or_b32 s54, s32, s33
    s_cbranch_scc1 L_nok_5
    s_cmp_ge_u32 s62, 200000
    s_cbranch_scc1 L_nok_5
    v_mov_b32 v94, 0
    buffer_load_dwordx2 v[92:93], v94, s[20:23], 0 offen sc1
    s_waitcnt vmcnt(0)
    s_branch L_nchk_4
L_nok_5:
    v_mov_b32 v1, 153600
    ds_write_b64 v1, v[92:93]
    v_add_u32 v1, 151552, v27
    ds_read_b32 v52, v1 offset:0
    ds_read_b32 v53, v1 offset:512
    ds_read_b32 v54, v1 offset:1024
    ds_read_b32 v55, v1 offset:1536
    s_add_u32 s54, s82, 0
    s_sub_u32 s55, s54, 10
    s_min_u32 s54, s54, s55
    s_lshl_b32 s54, s54, 10
    s_waitcnt lgkmcnt(0)
    v_add_f32 v52, v52, v53
    v_add_f32 v54, v54, v55
    v_mov_b32 v53, s32
    v_add_f32 v52, v52, v54
    s_mov_b64 exec, 0xffffffff
    buffer_store_dwordx2 v[52:53], v25, s[12:15], s54 offen sc1
    s_mov_b64 exec, -1
    s_barrier
    s_mov_b32 m0, s80
    s_add_u32 s54, s67, 81920
    buffer_load_dwordx4 v78, s[4:7], s67 offen lds
    s_add_u32 m0, m0, 8192
    s_add_u32 s55, s68, 122880
    buffer_load_dwordx4 v78, s[4:7], s54 offen lds
    s_add_u32 m0, m0, 8192
    s_add_u32 s80, s80, 32768
    buffer_load_dwordx4 v80, s[8:11], s68 offen lds
    s_add_u32 m0, m0, 8192
    s_add_u32 s68, s68, 15360
    buffer_load_dwordx4 v80, s[8:11], s55 offen lds
    s_sub_u32 m0, m0, 23552
    s_add_u32 s55, s55, 15360
    buffer_load_dwordx4 v79, s[4:7], s67 offen lds
    s_add_u32 m0, m0, 8192
    s_add_u32 s67, s67, 128
    buffer_load_dwordx4 v79, s[4:7], s54 offen lds
    s_add_u32 m0, m0, 8192
    s_and_b32 s80, s80, 0x1ffff
    buffer_load_dwordx4 v80, s[8:11], s68 offen lds
    s_add_u32 m0, m0, 8192
    s_add_u32 s68, s68, 230400
    buffer_load_dwordx4 v80, s[8:11], s55 offen lds
    s_sub_u32 s66, s66, 1
    s_cmov_b32 s67, s71
    s_cmov_b32 s68, s69
    v_mov_b32 v30, 0
    ds_read_b64_tr_b16 v[36:37], v20 offset:16384
    ds_read_b64_tr_b16 v[38:39], v20 offset:17408
    v_mov_b32 v31, 0
    ds_read_b64_tr_b16 v[40:41], v21 offset:16384
    ds_read_b64_tr_b16 v[42:43], v21 offset:17408
    v_mov_b32 v32, 0
    ds_read_b64_tr_b16 v[44:45], v22 offset:16384
    ds_read_b64_tr_b16 v[46:47], v22 offset:17408
    v_mov_b32 v33, 0
    ds_read_b64_tr_b16 v[48:49], v23 offset:16384
    ds_read_b64_tr_b16 v[50:51], v23 offset:17408
    s_waitcnt lgkmcnt(0)
    v_dot2_f32_bf16 v30, v36, v28, v30
    v_dot2_f32_bf16 v31, v40, v28, v31
    v_dot2_f32_bf16 v32, v44, v28, v32
    v_dot2_f32_bf16 v33, v48, v28, v33
    v_dot2_f32_bf16 v30, v37, v28, v30
    v_dot2_f32_bf16 v31, v41, v28, v31
    v_dot2_f32_bf16 v32, v45, v28, v32
    v_dot2_f32_bf16 v33, v49, v28, v33
    v_dot2_f32_bf16 v30, v38, v28, v30
    v_dot2_f32_bf16 v31, v42, v28, v31
    v_dot2_f32_bf16 v32, v46, v28, v32
    v_dot2_f32_bf16 v33, v50, v28, v33
    v_dot2_f32_bf16 v30, v39, v28, v30
    v_dot2_f32_bf16 v31, v43, v28, v31
    v_dot2_f32_bf16 v32, v47, v28, v32
    v_dot2_f32_bf16 v33, v51, v28, v33
    s_nop 2
    v_permlane32_swap_b32 v30, v31
    v_permlane32_swap_b32 v32, v33
    s_nop 0
    v_add_f32 v30, v30, v31
    v_add_f32 v32, v32, v33
    ds_write_b32 v24, v30 offset:0
    ds_write_b32 v24, v32 offset:256
    v_add_u32 v1, 151552, v27
    ds_read_b32 v52, v1 offset:6144
    ds_read_b32 v53, v1 offset:6656
    ds_read_b32 v54, v1 offset:7168
    ds_read_b32 v55, v1 offset:7680
    s_add_u32 s54, s82, 1
    s_sub_u32 s55, s54, 10
    s_min_u32 s54, s54, s55
    s_lshl_b32 s54, s54, 10
    s_waitcnt lgkmcnt(0)
    v_add_f32 v52, v52, v53
    v_add_f32 v54, v54, v55
    v_mov_b32 v53, s32
    v_add_f32 v52, v52, v54
    s_mov_b64 exec, 0xffffffff
    buffer_store_dwordx2 v[52:53], v25, s[12:15], s54 offen sc1
    s_mov_b64 exec, -1
    s_waitcnt vmcnt(10)
    s_barrier
    s_mov_b32 m0, s80
    s_add_u32 s54, s67, 81920
    buffer_load_dwordx4 v78, s[4:7], s67 offen lds
    s_add_u32 m0, m0, 8192
    s_add_u32 s55, s68, 122880
    buffer_load_dwordx4 v78, s[4:7], s54 offen lds
    s_add_u32 m0, m0, 8192
    s_add_u32 s80, s80, 32768
    buffer_load_dwordx4 v80, s[8:11], s68 offen lds
    s_add_u32 m0, m0, 8192
    s_add_u32 s68, s68, 15360
    buffer_load_dwordx4 v80, s[8:11], s55 offen lds
    s_sub_u32 m0, m0, 23552
    s_add_u32 s55, s55, 15360
    buffer_load_dwordx4 v79, s[4:7], s67 offen lds
    s_add_u32 m0, m0, 8192
    s_add_u32 s67, s67, 128
    buffer_load_dwordx4 v79, s[4:7], s54 offen lds
    s_add_u32 m0, m0, 8192
    s_and_b32 s80, s80, 0x1ffff
    buffer_load_dwordx4 v80, s[8:11], s68 offen lds
    s_add_u32 m0, m0, 8192
    s_add_u32 s68, s68, 230400
    buffer_load_dwordx4 v80, s[8:11], s55 offen lds
    s_sub_u32 s66, s66, 1
    s_cmov_b32 s67, s71
    s_cmov_b32 s68, s69
    v_add_u32 v1, 151552, v27
    ds_read_b32 v52, v1 offset:0
    ds_read_b32 v53, v1 offset:512
    ds_read_b32 v54, v1 offset:1024
    ds_read_b32 v55, v1 offset:1536
    s_add_u32 s54, s82, 2
    s_sub_u32 s55, s54, 10
    s_min_u32 s54, s54, s55
    s_lshl_b32 s54, s54, 10
    s_waitcnt lgkmcnt(0)
    v_add_f32 v52, v52, v53
    v_add_f32 v54, v54, v55
    v_mov_b32 v53, s32
    v_add_f32 v52, v52, v54
    s_mov_b64 exec, 0xffffffff
    buffer_store_dwordx2 v[52:53], v25, s[12:15], s54 offen sc1
    s_mov_b64 exec, -1
    s_waitcnt vmcnt(10)
    s_barrier
    s_mov_b32 m0, s80
    s_add_u32 s54, s67, 81920
    buffer_load_dwordx4 v78, s[4:7], s67 offen lds
    s_add_u32 m0, m0, 8192
    s_add_u32 s55, s68, 122880
    buffer_load_dwordx4 v78, s[4:7], s54 offen lds
    s_add_u32 m0, m0, 8192
    s_add_u32 s80, s80, 32768
    buffer_load_dwordx4 v80, s[8:11], s68 offen lds
    s_add_u32 m0, m0, 8192
    s_add_u32 s68, s68, 15360
    buffer_load_dwordx4 v80, s[8:11], s55 offen lds
    s_sub_u32 m0, m0, 23552
    s_add_u32 s55, s55, 15360
    buffer_load_dwordx4 v79, s[4:7], s67 offen lds
    s_add_u32 m0, m0, 8192
    s_add_u32 s67, s67, 128
    buffer_load_dwordx4 v79, s[4:7], s54 offen lds
    s_add_u32 m0, m0, 8192
    s_and_b32 s80, s80, 0x1ffff
    buffer_load_dwordx4 v80, s[8:11], s68 offen lds
    s_add_u32 m0, m0, 8192
    s_add_u32 s68, s68, 230400
    buffer_load_dwordx4 v80, s[8:11], s55 offen lds
    s_sub_u32 s66, s66, 1
    s_cmov_b32 s67, s71
    s_cmov_b32 s68, s69
    s_waitcnt vmcnt(9)
    s_mov_b32 s70, 4
L_p1_ld:
    s_barrier
    s_mov_b32 m0, s80
    s_add_u32 s54, s67, 81920
    buffer_load_dwordx4 v78, s[4:7], s67 offen lds
    s_add_u32 m0, m0, 8192
    s_add_u32 s55, s68, 122880
    buffer_load_dwordx4 v78, s[4:7], s54 offen lds
    s_add_u32 m0, m0, 8192
    s_add_u32 s80, s80, 32768
    buffer_load_dwordx4 v80, s[8:11], s68 offen lds
    s_add_u32 m0, m0, 8192
    s_add_u32 s68, s68, 15360
    buffer_load_dwordx4 v80, s[8:11], s55 offen lds
    s_sub_u32 m0, m0, 23552
    s_add_u32 s55, s55, 15360
    buffer_load_dwordx4 v79, s[4:7], s67 offen lds
    s_add_u32 m0, m0, 8192
    s_add_u32 s67, s67, 128
    buffer_load_dwordx4 v79, s[4:7], s54 offen lds
    s_add_u32 m0, m0, 8192
    s_and_b32 s80, s80, 0x1ffff
    buffer_load_dwordx4 v80, s[8:11], s68 offen lds
    s_add_u32 m0, m0, 8192
    s_add_u32 s68, s68, 230400
    buffer_load_dwordx4 v80, s[8:11], s55 offen lds
    s_sub_u32 s66, s66, 1
    s_cmov_b32 s67, s71
    s_cmov_b32 s68, s69
    s_add_u32 s70, s70, 1
    s_cmp_lt_u32 s70, 7
    s_cbranch_scc0 L_p1_ldx
    s_waitcnt vmcnt(8)
    s_branch L_p1_ld
L_p1_ldx:
    s_waitcnt vmcnt(8)
    s_barrier
    buffer_load_dwordx4 v[36:39], v26, s[12:15], 0 offen sc1
    s_movk_i32 s54, 0x1000
    s_movk_i32 s55, 0x2000
    buffer_load_dwordx2 v[40:41], v25, s[12:15], 0 offen offset:0 sc1
    buffer_load_dwordx2 v[42:43], v25, s[12:15], 0 offen offset:2048 sc1
    buffer_load_dwordx2 v[44:45], v25, s[12:15], s54 offen offset:0 sc1
    buffer_load_dwordx2 v[46:47], v25, s[12:15], s54 offen offset:2048 sc1
    buffer_load_dwordx2 v[48:49], v25, s[12:15], s55 offen offset:0 sc1
    s_waitcnt vmcnt(6)
    s_barrier
    s_mov_b32 s62, 0
L_p1_gchk:
    s_waitcnt vmcnt(0)
    v_xor_b32 v2, s32, v37
    v_xor_b32 v3, s32, v39
    v_xor_b32 v4, s32, v41
    v_or3_b32 v2, v2, v3, v4
    v_xor_b32 v4, s32, v43
    v_or3_b32 v2, v2, v3, v4
    v_xor_b32 v4, s32, v45
    v_or3_b32 v2, v2, v3, v4
    v_xor_b32 v4, s32, v47
    v_or3_b32 v2, v2, v3, v4
    v_xor_b32 v4, s32, v49
    v_or3_b32 v2, v2, v3, v4
    v_cmp_ne_u32 vcc, 0, v2
    s_cbranch_vccz L_p1_gok
    s_add_u32 s62, s62, 1
    s_cmp_ge_u32 s62, 200000
    s_cbranch_scc1 L_p1_gok
    buffer_load_dwordx4 v[36:39], v26, s[12:15], 0 offen sc1
    s_movk_i32 s54, 0x1000
    s_movk_i32 s55, 0x2000
    buffer_load_dwordx2 v[40:41], v25, s[12:15], 0 offen offset:0 sc1
    buffer_load_dwordx2 v[42:43], v25, s[12:15], 0 offen offset:2048 sc1
    buffer_load_dwordx2 v[44:45], v25, s[12:15], s54 offen offset:0 sc1
    buffer_load_dwordx2 v[46:47], v25, s[12:15], s54 offen offset:2048 sc1
    buffer_load_dwordx2 v[48:49], v25, s[12:15], s55 offen offset:0 sc1
    s_branch L_p1_gchk
L_p1_gok:
    v_add_f32 v40, v40, v42
    v_add_f32 v44, v44, v46
    v_add_f32 v40, v40, v48
    v_add_f32 v40, v40, v44
    s_cmp_lt_u32 s65, 5
    s_cselect_b32 s55, 0x3ea52b5c, 1.0
    v_mov_b32 v41, v40
    v_mul_f32 v36, s55, v36
    v_mul_f32 v37, s55, v38
    v_permlane32_swap_b32 v40, v41
    v_lshlrev_b32 v1, 1, v27
    v_add_f32 v40, v40, v41
    v_add_u32 v1, 154624, v1
    v_add_u32 v27, 154112, v27
    ds_write_b32 v27, v40
    ds_write_b64 v1, v[36:37]
    ds_write_b32 v27, v36 offset:1536
    ds_write_b32 v27, v37 offset:2048
    s_waitcnt lgkmcnt(0)
    s_barrier
    s_branch L_p1_done
L_p1_c:
    s_and_b32 s72, s28, 1
    s_bfe_u32 s73, s28, 0x10001
    s_cmp_ge_u32 s65, 5
    s_cselect_b32 s54, 5, 0
    s_sub_u32 s54, s65, s54
    s_lshl_b32 s54, s54, 1
    s_add_u32 s54, s54, s73
    s_cmp_eq_u32 s54, 0
    s_cbranch_scc1 L_tab0
    s_cmp_eq_u32 s54, 1
    s_cbranch_scc1 L_tab1
    s_cmp_eq_u32 s54, 2
    s_cbranch_scc1 L_tab2
    s_cmp_eq_u32 s54, 3
    s_cbranch_scc1 L_tab3
    s_cmp_eq_u32 s54, 4
    s_cbranch_scc1 L_tab4
    s_cmp_eq_u32 s54, 5
    s_cbranch_scc1 L_tab5
    s_cmp_eq_u32 s54, 6
    s_cbranch_scc1 L_tab6
    s_cmp_eq_u32 s54, 7
    s_cbranch_scc1 L_tab7
    s_cmp_eq_u32 s54, 8
    s_cbranch_scc1 L_tab8
    s_cmp_eq_u32 s54, 9
    s_cbranch_scc1 L_tab9
    s_mul_i32 s55, s73, 0x10101010
    s_add_u32 s74, s55, 0x03020100
    s_add_u32 s75, s55, 0x07060504
    s_add_u32 s76, s55, 0x0b0a0908
    s_add_u32 s77, s55, 0x0f0e0d0c
    s_mov_b32 s78, 0
    s_mov_b32 s79, 0
    s_branch L_tabdone
L_tab0:
    s_mov_b32 s74, 0x03010200
    s_mov_b32 s75, 0x170d160c
    s_mov_b32 s76, 0x08060705
    s_mov_b32 s77, 0x090b040a
    s_mov_b32 s78, 0x09050100
    s_mov_b32 s79, 0x40040302
    s_branch L_tabdone
L_tab1:
    s_mov_b32 s74, 0x1210110f
    s_mov_b32 s75, 0x13150e14
    s_mov_b32 s76, 0x1c1a1b19
    s_mov_b32 s77, 0x1d1f181e
    s_mov_b32 s78, 0x41080706
    s_mov_b32 s79, 0x420c0b0a
    s_branch L_tabdone
L_tab2:
    s_mov_b32 s74, 0x04010300
    s_mov_b32 s75, 0x07060205
    s_mov_b32 s76, 0x0b090a08
    s_mov_b32 s77, 0x1f151e14
    s_mov_b32 s78, 0x430f0e0d
    s_mov_b32 s79, 0x19151110
    s_branch L_tabdone
L_tab3:
    s_mov_b32 s74, 0x100e0f0d
    s_mov_b32 s75, 0x11130c12
    s_mov_b32 s76, 0x1a181917
    s_mov_b32 s77, 0x1b1d161c
    s_mov_b32 s78, 0x44141312
    s_mov_b32 s79, 0x45181716
    s_branch L_tabdone
L_tab4:
    s_mov_b32 s74, 0x04020301
    s_mov_b32 s75, 0x05070006
    s_mov_b32 s76, 0x0c090b08
    s_mov_b32 s77, 0x0f0e0a0d
    s_mov_b32 s78, 0x461c1b1a
    s_mov_b32 s79, 0x471f1e1d
    s_branch L_tabdone
L_tab5:
    s_mov_b32 s74, 0x13111210
    s_mov_b32 s75, 0x1f1d1e1c
    s_mov_b32 s76, 0x18161715
    s_mov_b32 s77, 0x191b141a
    s_mov_b32 s78, 0x49252120
    s_mov_b32 s79, 0x48242322
    s_branch L_tabdone
L_tab6:
    s_mov_b32 s74, 0x03010200
    s_mov_b32 s75, 0x07050604
    s_mov_b32 s76, 0x0c0a0b09
    s_mov_b32 s77, 0x0d0f080e
    s_mov_b32 s78, 0x29282726
    s_mov_b32 s79, 0x4a2c2b2a
    s_branch L_tabdone
L_tab7:
    s_mov_b32 s74, 0x14111310
    s_mov_b32 s75, 0x17161215
    s_mov_b32 s76, 0x1b191a18
    s_mov_b32 s77, 0x1f1e1c1d
    s_mov_b32 s78, 0x4b2f2e2d
    s_mov_b32 s79, 0x4c323130
    s_branch L_tabdone
L_tab8:
    s_mov_b32 s74, 0x03010200
    s_mov_b32 s75, 0x0f050e04
    s_mov_b32 s76, 0x0a080907
    s_mov_b32 s77, 0x0b0d060c
    s_mov_b32 s78, 0x39353433
    s_mov_b32 s79, 0x4d383736
    s_branch L_tabdone
L_tab9:
    s_mov_b32 s74, 0x14121311
    s_mov_b32 s75, 0x15171016
    s_mov_b32 s76, 0x1c191b18
    s_mov_b32 s77, 0x1f1e1a1d
    s_mov_b32 s78, 0x4e3c3b3a
    s_mov_b32 s79, 0x4f3f3e3d
L_tabdone:
    v_and_b32 v1, 31, v0
    s_lshl_b32 s54, s72, 6
    v_add_u32 v2, s54, v1
    v_bfe_u32 v3, v2, 1, 3
    v_lshrrev_b32 v4, 5, v0
    v_xor_b32 v3, v3, v4
    v_lshlrev_b32 v3, 4, v3
    v_lshl_add_u32 v80, v2, 7, v3
    v_xor_b32 v81, 32, v80
    v_xor_b32 v82, 64, v80
    v_xor_b32 v83, 96, v80
    v_lshlrev_b32 v87, 3, v2
    v_add_u32 v87, 154624, v87
    v_bfe_u32 v5, v0, 2, 2
    v_lshl_add_u32 v6, v4, 3, v5
    v_lshlrev_b32 v6, 8, v6
    v_and_b32 v7, 3, v0
    v_lshlrev_b32 v7, 3, v7
    v_and_b32 v8, 16, v0
    v_cmp_ne_u32 vcc, 0, v8
    v_mov_b32 v8, s74
    v_mov_b32 v9, s75
    v_cndmask_b32 v8, v8, v9, vcc
    v_bfe_u32 v8, v8, v7, 8
    v_lshlrev_b32 v8, 3, v8
    v_lshlrev_b32 v9, 6, v5
    v_xor_b32 v8, v8, v9
    v_add_u32 v84, v6, v8
    v_mov_b32 v8, s76
    v_mov_b32 v9, s77
    v_cndmask_b32 v8, v8, v9, vcc
    v_bfe_u32 v8, v8, v7, 8
    v_lshlrev_b32 v8, 3, v8
    v_lshlrev_b32 v9, 6, v5
    v_xor_b32 v8, v8, v9
    v_add_u32 v85, v6, v8
    s_lshl_b32 s54, s64, 2
    s_lshl_b32 s55, s72, 1
    s_add_u32 s54, s54, s55
    s_cmp_ge_u32 s65, 10
    s_cbranch_scc1 L_p1_vaddr
    s_lshl_b32 s54, s54, 9
    s_cmp_ge_u32 s65, 5
    s_cselect_b32 s55, 2621440, 0
    s_add_u32 s54, s54, s55
    v_lshl_add_u32 v2, v1, 4, s54
    v_lshlrev_b32 v3, 3, v4
    v_add_u32 v5, 16, v3
    v_mov_b32 v7, 154112
    v_bfe_u32 v6, s78, v3, 8
    v_lshl_add_u32 v88, v6, 15, v2
    v_bfe_u32 v6, s78, v5, 8
    v_lshl_add_u32 v89, v6, 15, v2
    v_bfe_u32 v6, s74, v3, 8
    v_lshl_add_u32 v92, v6, 4, v7
    v_bfe_u32 v6, s74, v5, 8
    v_lshl_add_u32 v93, v6, 4, v7
    v_bfe_u32 v6, s75, v3, 8
    v_lshl_add_u32 v94, v6, 4, v7
    v_bfe_u32 v6, s75, v5, 8
    v_lshl_add_u32 v95, v6, 4, v7
    v_bfe_u32 v6, s79, v3, 8
    v_lshl_add_u32 v90, v6, 15, v2
    v_bfe_u32 v6, s79, v5, 8
    v_lshl_add_u32 v91, v6, 15, v2
    v_bfe_u32 v6, s76, v3, 8
    v_lshl_add_u32 v96, v6, 4, v7
    v_bfe_u32 v6, s76, v5, 8
    v_lshl_add_u32 v97, v6, 4, v7
    v_bfe_u32 v6, s77, v3, 8
    v_lshl_add_u32 v98, v6, 4, v7
    v_bfe_u32 v6, s77, v5, 8
    v_lshl_add_u32 v99, v6, 4, v7
    s_branch L_p1_addrdone
L_p1_vaddr:
    s_mul_i32 s54, s54, 1280
    s_add_u32 s54, s54, 5242880
    s_lshl_b32 s55, s65, 7
    s_lshl_b32 s56, s73, 6
    s_add_u32 s55, s55, s56
    s_sub_u32 s55, s55, 1280
    v_mov_b32 v90, 0
    v_mov_b32 v91, 0
    s_lshl_b32 s56, s56, 2
    s_add_u32 s56, s56, 154112
    v_lshl_add_u32 v92, v1, 2, s56
    s_lshl_b32 s56, s72, 8
    s_add_u32 s56, s56, 155648
    v_lshl_add_u32 v93, v4, 4, s56
    v_mul_u32_u24 v3, 320, v4
    v_add_u32 v3, s54, v3
    s_mov_b32 s56, 81920
    v_add_u32 v5, s55, v1
    v_mul_u32_u24 v6, 3277, v5
    v_lshrrev_b32 v6, 16, v6
    v_mul_u32_u24 v7, 20, v6
    v_sub_u32 v5, v5, v7
    v_lshl_add_u32 v5, v5, 4, v3
    v_mad_u32_u24 v88, v6, s56, v5
    v_add_u32 v5, s55, v1
    v_add_u32 v5, 32, v5
    v_mul_u32_u24 v6, 3277, v5
    v_lshrrev_b32 v6, 16, v6
    v_mul_u32_u24 v7, 20, v6
    v_sub_u32 v5, v5, v7
    v_lshl_add_u32 v5, v5, 4, v3
    v_mad_u32_u24 v89, v6, s56, v5
L_p1_addrdone:
    v_mov_b32 v16, 0
    v_mov_b32 v17, 0
    v_mov_b32 v18, 0
    v_mov_b32 v19, 0
    v_mov_b32 v20, 0
    v_mov_b32 v21, 0
    v_mov_b32 v22, 0
    v_mov_b32 v23, 0
    v_mov_b32 v24, 0
    v_mov_b32 v25, 0
    v_mov_b32 v26, 0
    v_mov_b32 v27, 0
    v_mov_b32 v28, 0
    v_mov_b32 v29, 0
    v_mov_b32 v30, 0
    v_mov_b32 v31, 0
    v_mov_b32 v32, 0
    v_mov_b32 v33, 0
    v_mov_b32 v34, 0
    v_mov_b32 v35, 0
    v_mov_b32 v36, 0
    v_mov_b32 v37, 0
    v_mov_b32 v38, 0
    v_mov_b32 v39, 0
    v_mov_b32 v40, 0
    v_mov_b32 v41, 0
    v_mov_b32 v42, 0
    v_mov_b32 v43, 0
    v_mov_b32 v44, 0
    v_mov_b32 v45, 0
    v_mov_b32 v46, 0
    v_mov_b32 v47, 0
    v_mov_b32 v48, 0
    v_mov_b32 v49, 0
    v_mov_b32 v50, 0
    v_mov_b32 v51, 0
    v_mov_b32 v52, 0
    v_mov_b32 v53, 0
    v_mov_b32 v54, 0
    v_mov_b32 v55, 0
    v_mov_b32 v56, 0
    v_mov_b32 v57, 0
    v_mov_b32 v58, 0
    v_mov_b32 v59, 0
    v_mov_b32 v60, 0
    v_mov_b32 v61, 0
    v_mov_b32 v62, 0
    v_mov_b32 v63, 0
    v_mov_b32 v64, 0
    v_mov_b32 v65, 0
    v_mov_b32 v66, 0
    v_mov_b32 v67, 0
    v_mov_b32 v68, 0
    v_mov_b32 v69, 0
    v_mov_b32 v70, 0
    v_mov_b32 v71, 0
    v_mov_b32 v72, 0
    v_mov_b32 v73, 0
    v_mov_b32 v74, 0
    v_mov_b32 v75, 0
    v_mov_b32 v76, 0
    v_mov_b32 v77, 0
    v_mov_b32 v78, 0
    v_mov_b32 v79, 0
    v_mov_b32 v86, 0x8000
    s_mov_b32 s70, 0
    s_waitcnt vmcnt(0)
    s_barrier
    ds_read_b128 v[160:163], v80 offset:0
    ds_read_b128 v[164:167], v80 offset:4096
    ds_read_b64_tr_b16 v[192:193], v84 offset:16384
    ds_read_b64_tr_b16 v[194:195], v84 offset:17408
    ds_read_b64_tr_b16 v[196:197], v85 offset:16384
    ds_read_b64_tr_b16 v[198:199], v85 offset:17408
    ds_read_b128 v[168:171], v81 offset:0
    ds_read_b128 v[172:175], v81 offset:4096
    ds_read_b64_tr_b16 v[200:201], v84 offset:20480
    ds_read_b64_tr_b16 v[202:203], v84 offset:21504
    ds_read_b64_tr_b16 v[204:205], v85 offset:20480
    ds_read_b64_tr_b16 v[206:207], v85 offset:21504
    v_xor_b32 v80, v86, v80
    v_xor_b32 v81, v86, v81
    s_cmp_ge_u32 s65, 10
    s_cbranch_scc1 L_p1_v
.p2align 3
L_p1loop_6:
    s_waitcnt lgkmcnt(6)
    v_mfma_f32_32x32x16_bf16 v[16:31], v[192:195], v[160:163], v[16:31]
    ds_read_b128 v[176:179], v82 offset:0
    ds_read_b128 v[180:183], v82 offset:4096
    v_mfma_f32_32x32x16_bf16 v[32:47], v[192:195], v[164:167], v[32:47]
    ds_read_b64_tr_b16 v[208:209], v84 offset:24576
    ds_read_b64_tr_b16 v[210:211], v84 offset:25600
    v_mfma_f32_32x32x16_bf16 v[48:63], v[196:199], v[160:163], v[48:63]
    ds_read_b64_tr_b16 v[212:213], v85 offset:24576
    ds_read_b64_tr_b16 v[214:215], v85 offset:25600
    v_mfma_f32_32x32x16_bf16 v[64:79], v[196:199], v[164:167], v[64:79]
    v_xor_b32 v82, v86, v82
    s_waitcnt lgkmcnt(6)
    v_mfma_f32_32x32x16_bf16 v[16:31], v[200:203], v[168:171], v[16:31]
    ds_read_b128 v[184:187], v83 offset:0
    ds_read_b128 v[188:191], v83 offset:4096
    v_mfma_f32_32x32x16_bf16 v[32:47], v[200:203], v[172:175], v[32:47]
    ds_read_b64_tr_b16 v[216:217], v84 offset:28672
    ds_read_b64_tr_b16 v[218:219], v84 offset:29696
    v_mfma_f32_32x32x16_bf16 v[48:63], v[204:207], v[168:171], v[48:63]
    ds_read_b64_tr_b16 v[220:221], v85 offset:28672
    ds_read_b64_tr_b16 v[222:223], v85 offset:29696
    v_mfma_f32_32x32x16_bf16 v[64:79], v[204:207], v[172:175], v[64:79]
    v_xor_b32 v83, v86, v83
    v_xor_b32 v84, v86, v84
    v_xor_b32 v85, v86, v85
    v_xor_b32 v86, 0x10000, v86
    s_waitcnt lgkmcnt(6)
    v_mfma_f32_32x32x16_bf16 v[16:31], v[208:211], v[176:179], v[16:31]
    s_barrier
    ds_read_b128 v[160:163], v80 offset:0
    ds_read_b128 v[164:167], v80 offset:4096
    v_mfma_f32_32x32x16_bf16 v[32:47], v[208:211], v[180:183], v[32:47]
    ds_read_b64_tr_b16 v[192:193], v84 offset:16384
    ds_read_b64_tr_b16 v[194:195], v84 offset:17408
    v_mfma_f32_32x32x16_bf16 v[48:63], v[212:215], v[176:179], v[48:63]
    ds_read_b64_tr_b16 v[196:197], v85 offset:16384
    ds_read_b64_tr_b16 v[198:199], v85 offset:17408
    v_mfma_f32_32x32x16_bf16 v[64:79], v[212:215], v[180:183], v[64:79]
    v_xor_b32 v80, v86, v80
    s_waitcnt lgkmcnt(6)
    v_mfma_f32_32x32x16_bf16 v[16:31], v[216:219], v[184:187], v[16:31]
    ds_read_b128 v[168:171], v81 offset:0
    ds_read_b128 v[172:175], v81 offset:4096
    v_mfma_f32_32x32x16_bf16 v[32:47], v[216:219], v[188:191], v[32:47]
    ds_read_b64_tr_b16 v[200:201], v84 offset:20480
    ds_read_b64_tr_b16 v[202:203], v84 offset:21504
    v_mfma_f32_32x32x16_bf16 v[48:63], v[220:223], v[184:187], v[48:63]
    ds_read_b64_tr_b16 v[204:205], v85 offset:20480
    ds_read_b64_tr_b16 v[206:207], v85 offset:21504
    v_mfma_f32_32x32x16_bf16 v[64:79], v[220:223], v[188:191], v[64:79]
    v_xor_b32 v81, v86, v81
    s_add_u32 s70, s70, 1
    s_cmp_lt_u32 s70, 9
    s_cbranch_scc1 L_p1loop_6
    s_waitcnt lgkmcnt(6)
    v_mfma_f32_32x32x16_bf16 v[16:31], v[192:195], v[160:163], v[16:31]
    ds_read_b128 v[176:179], v82 offset:0
    ds_read_b128 v[180:183], v82 offset:4096
    v_mfma_f32_32x32x16_bf16 v[32:47], v[192:195], v[164:167], v[32:47]
    ds_read_b64_tr_b16 v[208:209], v84 offset:24576
    ds_read_b64_tr_b16 v[210:211], v84 offset:25600
    v_mfma_f32_32x32x16_bf16 v[48:63], v[196:199], v[160:163], v[48:63]
    ds_read_b64_tr_b16 v[212:213], v85 offset:24576
    ds_read_b64_tr_b16 v[214:215], v85 offset:25600
    v_mfma_f32_32x32x16_bf16 v[64:79], v[196:199], v[164:167], v[64:79]
    v_xor_b32 v82, v86, v82
    s_waitcnt lgkmcnt(6)
    v_mfma_f32_32x32x16_bf16 v[16:31], v[200:203], v[168:171], v[16:31]
    ds_read_b128 v[184:187], v83 offset:0
    ds_read_b128 v[188:191], v83 offset:4096
    v_mfma_f32_32x32x16_bf16 v[32:47], v[200:203], v[172:175], v[32:47]
    ds_read_b64_tr_b16 v[216:217], v84 offset:28672
    ds_read_b64_tr_b16 v[218:219], v84 offset:29696
    v_mfma_f32_32x32x16_bf16 v[48:63], v[204:207], v[168:171], v[48:63]
    ds_read_b64_tr_b16 v[220:221], v85 offset:28672
    ds_read_b64_tr_b16 v[222:223], v85 offset:29696
    v_mfma_f32_32x32x16_bf16 v[64:79], v[204:207], v[172:175], v[64:79]
    v_xor_b32 v83, v86, v83
    v_xor_b32 v84, v86, v84
    v_xor_b32 v85, v86, v85
    v_xor_b32 v86, 0x10000, v86
    s_waitcnt lgkmcnt(6)
    v_mfma_f32_32x32x16_bf16 v[16:31], v[208:211], v[176:179], v[16:31]
    v_mfma_f32_32x32x16_bf16 v[32:47], v[208:211], v[180:183], v[32:47]
    v_mfma_f32_32x32x16_bf16 v[48:63], v[212:215], v[176:179], v[48:63]
    v_mfma_f32_32x32x16_bf16 v[64:79], v[212:215], v[180:183], v[64:79]
    s_waitcnt lgkmcnt(0)
    v_mfma_f32_32x32x16_bf16 v[16:31], v[216:219], v[184:187], v[16:31]
    s_barrier
    v_mov_b32 v1, 153600
    ds_read_b64 v[2:3], v1
    ds_read_b64 v[12:13], v87
    ds_read_b64 v[14:15], v87 offset:256
    ds_read_b128 v[100:103], v92
    ds_read_b128 v[104:107], v93
    ds_read_b128 v[108:111], v94
    ds_read_b128 v[112:115], v95
    ds_read_b128 v[116:119], v96
    ds_read_b128 v[120:123], v97
    ds_read_b128 v[124:127], v98
    ds_read_b128 v[128:131], v99
    v_mfma_f32_32x32x16_bf16 v[32:47], v[216:219], v[188:191], v[32:47]
    v_mfma_f32_32x32x16_bf16 v[48:63], v[220:223], v[184:187], v[48:63]
    v_mfma_f32_32x32x16_bf16 v[64:79], v[220:223], v[188:191], v[64:79]
    s_waitcnt lgkmcnt(0)
    v_readfirstlane_b32 s32, v2
    v_readfirstlane_b32 s33, v3
    s_nop 5
    v_pk_mul_f32 v[16:17], v[12:13], v[16:17] op_sel_hi:[0,1]
    v_pk_mul_f32 v[18:19], v[12:13], v[18:19] op_sel_hi:[0,1]
    v_pk_mul_f32 v[20:21], v[12:13], v[20:21] op_sel_hi:[0,1]
    v_pk_mul_f32 v[22:23], v[12:13], v[22:23] op_sel_hi:[0,1]
    v_pk_fma_f32 v[16:17], v[12:13], v[100:101], v[16:17] op_sel:[1,0,0] op_sel_hi:[1,1,1] neg_lo:[1,0,0] neg_hi:[1,0,0]
    v_pk_fma_f32 v[18:19], v[12:13], v[102:103], v[18:19] op_sel:[1,0,0] op_sel_hi:[1,1,1] neg_lo:[1,0,0] neg_hi:[1,0,0]
    v_pk_fma_f32 v[20:21], v[12:13], v[104:105], v[20:21] op_sel:[1,0,0] op_sel_hi:[1,1,1] neg_lo:[1,0,0] neg_hi:[1,0,0]
    v_pk_fma_f32 v[22:23], v[12:13], v[106:107], v[22:23] op_sel:[1,0,0] op_sel_hi:[1,1,1] neg_lo:[1,0,0] neg_hi:[1,0,0]
    v_cvt_pk_bf16_f32 v4, v16, v17
    v_cvt_pk_bf16_f32 v5, v18, v19
    v_cvt_pk_bf16_f32 v6, v20, v21
    v_cvt_pk_bf16_f32 v7, v22, v23
    buffer_store_dwordx4 v[4:7], v88, s[12:15], 0 offen offset:0 sc1
    v_pk_mul_f32 v[24:25], v[12:13], v[24:25] op_sel_hi:[0,1]
    v_pk_mul_f32 v[26:27], v[12:13], v[26:27] op_sel_hi:[0,1]
    v_pk_mul_f32 v[28:29], v[12:13], v[28:29] op_sel_hi:[0,1]
    v_pk_mul_f32 v[30:31], v[12:13], v[30:31] op_sel_hi:[0,1]
    v_pk_fma_f32 v[24:25], v[12:13], v[108:109], v[24:25] op_sel:[1,0,0] op_sel_hi:[1,1,1] neg_lo:[1,0,0] neg_hi:[1,0,0]
    v_pk_fma_f32 v[26:27], v[12:13], v[110:111], v[26:27] op_sel:[1,0,0] op_sel_hi:[1,1,1] neg_lo:[1,0,0] neg_hi:[1,0,0]
    v_pk_fma_f32 v[28:29], v[12:13], v[112:113], v[28:29] op_sel:[1,0,0] op_sel_hi:[1,1,1] neg_lo:[1,0,0] neg_hi:[1,0,0]
    v_pk_fma_f32 v[30:31], v[12:13], v[114:115], v[30:31] op_sel:[1,0,0] op_sel_hi:[1,1,1] neg_lo:[1,0,0] neg_hi:[1,0,0]
    v_cvt_pk_bf16_f32 v8, v24, v25
    v_cvt_pk_bf16_f32 v9, v26, v27
    v_cvt_pk_bf16_f32 v10, v28, v29
    v_cvt_pk_bf16_f32 v11, v30, v31
    buffer_store_dwordx4 v[8:11], v89, s[12:15], 0 offen offset:0 sc1
    v_pk_mul_f32 v[32:33], v[14:15], v[32:33] op_sel_hi:[0,1]
    v_pk_mul_f32 v[34:35], v[14:15], v[34:35] op_sel_hi:[0,1]
    v_pk_mul_f32 v[36:37], v[14:15], v[36:37] op_sel_hi:[0,1]
    v_pk_mul_f32 v[38:39], v[14:15], v[38:39] op_sel_hi:[0,1]
    v_pk_fma_f32 v[32:33], v[14:15], v[100:101], v[32:33] op_sel:[1,0,0] op_sel_hi:[1,1,1] neg_lo:[1,0,0] neg_hi:[1,0,0]
    v_pk_fma_f32 v[34:35], v[14:15], v[102:103], v[34:35] op_sel:[1,0,0] op_sel_hi:[1,1,1] neg_lo:[1,0,0] neg_hi:[1,0,0]
    v_pk_fma_f32 v[36:37], v[14:15], v[104:105], v[36:37] op_sel:[1,0,0] op_sel_hi:[1,1,1] neg_lo:[1,0,0] neg_hi:[1,0,0]
    v_pk_fma_f32 v[38:39], v[14:15], v[106:107], v[38:39] op_sel:[1,0,0] op_sel_hi:[1,1,1] neg_lo:[1,0,0] neg_hi:[1,0,0]
    v_cvt_pk_bf16_f32 v4, v32, v33
    v_cvt_pk_bf16_f32 v5, v34, v35
    v_cvt_pk_bf16_f32 v6, v36, v37
    v_cvt_pk_bf16_f32 v7, v38, v39
    buffer_store_dwordx4 v[4:7], v88, s[12:15], 0 offen offset:512 sc1
    v_pk_mul_f32 v[40:41], v[14:15], v[40:41] op_sel_hi:[0,1]
    v_pk_mul_f32 v[42:43], v[14:15], v[42:43] op_sel_hi:[0,1]
    v_pk_mul_f32 v[44:45], v[14:15], v[44:45] op_sel_hi:[0,1]
    v_pk_mul_f32 v[46:47], v[14:15], v[46:47] op_sel_hi:[0,1]
    v_pk_fma_f32 v[40:41], v[14:15], v[108:109], v[40:41] op_sel:[1,0,0] op_sel_hi:[1,1,1] neg_lo:[1,0,0] neg_hi:[1,0,0]
    v_pk_fma_f32 v[42:43], v[14:15], v[110:111], v[42:43] op_sel:[1,0,0] op_sel_hi:[1,1,1] neg_lo:[1,0,0] neg_hi:[1,0,0]
    v_pk_fma_f32 v[44:45], v[14:15], v[112:113], v[44:45] op_sel:[1,0,0] op_sel_hi:[1,1,1] neg_lo:[1,0,0] neg_hi:[1,0,0]
    v_pk_fma_f32 v[46:47], v[14:15], v[114:115], v[46:47] op_sel:[1,0,0] op_sel_hi:[1,1,1] neg_lo:[1,0,0] neg_hi:[1,0,0]
    v_cvt_pk_bf16_f32 v8, v40, v41
    v_cvt_pk_bf16_f32 v9, v42, v43
    v_cvt_pk_bf16_f32 v10, v44, v45
    v_cvt_pk_bf16_f32 v11, v46, v47
    buffer_store_dwordx4 v[8:11], v89, s[12:15], 0 offen offset:512 sc1
    v_pk_mul_f32 v[48:49], v[12:13], v[48:49] op_sel_hi:[0,1]
    v_pk_mul_f32 v[50:51], v[12:13], v[50:51] op_sel_hi:[0,1]
    v_pk_mul_f32 v[52:53], v[12:13], v[52:53] op_sel_hi:[0,1]
    v_pk_mul_f32 v[54:55], v[12:13], v[54:55] op_sel_hi:[0,1]
    v_pk_fma_f32 v[48:49], v[12:13], v[116:117], v[48:49] op_sel:[1,0,0] op_sel_hi:[1,1,1] neg_lo:[1,0,0] neg_hi:[1,0,0]
    v_pk_fma_f32 v[50:51], v[12:13], v[118:119], v[50:51] op_sel:[1,0,0] op_sel_hi:[1,1,1] neg_lo:[1,0,0] neg_hi:[1,0,0]
    v_pk_fma_f32 v[52:53], v[12:13], v[120:121], v[52:53] op_sel:[1,0,0] op_sel_hi:[1,1,1] neg_lo:[1,0,0] neg_hi:[1,0,0]
    v_pk_fma_f32 v[54:55], v[12:13], v[122:123], v[54:55] op_sel:[1,0,0] op_sel_hi:[1,1,1] neg_lo:[1,0,0] neg_hi:[1,0,0]
    v_cvt_pk_bf16_f32 v4, v48, v49
    v_cvt_pk_bf16_f32 v5, v50, v51
    v_cvt_pk_bf16_f32 v6, v52, v53
    v_cvt_pk_bf16_f32 v7, v54, v55
    buffer_store_dwordx4 v[4:7], v90, s[12:15], 0 offen offset:0 sc1
    v_pk_mul_f32 v[56:57], v[12:13], v[56:57] op_sel_hi:[0,1]
    v_pk_mul_f32 v[58:59], v[12:13], v[58:59] op_sel_hi:[0,1]
    v_pk_mul_f32 v[60:61], v[12:13], v[60:61] op_sel_hi:[0,1]
    v_pk_mul_f32 v[62:63], v[12:13], v[62:63] op_sel_hi:[0,1]
    v_pk_fma_f32 v[56:57], v[12:13], v[124:125], v[56:57] op_sel:[1,0,0] op_sel_hi:[1,1,1] neg_lo:[1,0,0] neg_hi:[1,0,0]
    v_pk_fma_f32 v[58:59], v[12:13], v[126:127], v[58:59] op_sel:[1,0,0] op_sel_hi:[1,1,1] neg_lo:[1,0,0] neg_hi:[1,0,0]
    v_pk_fma_f32 v[60:61], v[12:13], v[128:129], v[60:61] op_sel:[1,0,0] op_sel_hi:[1,1,1] neg_lo:[1,0,0] neg_hi:[1,0,0]
    v_pk_fma_f32 v[62:63], v[12:13], v[130:131], v[62:63] op_sel:[1,0,0] op_sel_hi:[1,1,1] neg_lo:[1,0,0] neg_hi:[1,0,0]
    v_cvt_pk_bf16_f32 v8, v56, v57
    v_cvt_pk_bf16_f32 v9, v58, v59
    v_cvt_pk_bf16_f32 v10, v60, v61
    v_cvt_pk_bf16_f32 v11, v62, v63
    buffer_store_dwordx4 v[8:11], v91, s[12:15], 0 offen offset:0 sc1
    v_pk_mul_f32 v[64:65], v[14:15], v[64:65] op_sel_hi:[0,1]
    v_pk_mul_f32 v[66:67], v[14:15], v[66:67] op_sel_hi:[0,1]
    v_pk_mul_f32 v[68:69], v[14:15], v[68:69] op_sel_hi:[0,1]
    v_pk_mul_f32 v[70:71], v[14:15], v[70:71] op_sel_hi:[0,1]
    v_pk_fma_f32 v[64:65], v[14:15], v[116:117], v[64:65] op_sel:[1,0,0] op_sel_hi:[1,1,1] neg_lo:[1,0,0] neg_hi:[1,0,0]
    v_pk_fma_f32 v[66:67], v[14:15], v[118:119], v[66:67] op_sel:[1,0,0] op_sel_hi:[1,1,1] neg_lo:[1,0,0] neg_hi:[1,0,0]
    v_pk_fma_f32 v[68:69], v[14:15], v[120:121], v[68:69] op_sel:[1,0,0] op_sel_hi:[1,1,1] neg_lo:[1,0,0] neg_hi:[1,0,0]
    v_pk_fma_f32 v[70:71], v[14:15], v[122:123], v[70:71] op_sel:[1,0,0] op_sel_hi:[1,1,1] neg_lo:[1,0,0] neg_hi:[1,0,0]
    v_cvt_pk_bf16_f32 v4, v64, v65
    v_cvt_pk_bf16_f32 v5, v66, v67
    v_cvt_pk_bf16_f32 v6, v68, v69
    v_cvt_pk_bf16_f32 v7, v70, v71
    buffer_store_dwordx4 v[4:7], v90, s[12:15], 0 offen offset:512 sc1
    v_pk_mul_f32 v[72:73], v[14:15], v[72:73] op_sel_hi:[0,1]
    v_pk_mul_f32 v[74:75], v[14:15], v[74:75] op_sel_hi:[0,1]
    v_pk_mul_f32 v[76:77], v[14:15], v[76:77] op_sel_hi:[0,1]
    v_pk_mul_f32 v[78:79], v[14:15], v[78:79] op_sel_hi:[0,1]
    v_pk_fma_f32 v[72:73], v[14:15], v[124:125], v[72:73] op_sel:[1,0,0] op_sel_hi:[1,1,1] neg_lo:[1,0,0] neg_hi:[1,0,0]
    v_pk_fma_f32 v[74:75], v[14:15], v[126:127], v[74:75] op_sel:[1,0,0] op_sel_hi:[1,1,1] neg_lo:[1,0,0] neg_hi:[1,0,0]
    v_pk_fma_f32 v[76:77], v[14:15], v[128:129], v[76:77] op_sel:[1,0,0] op_sel_hi:[1,1,1] neg_lo:[1,0,0] neg_hi:[1,0,0]
    v_pk_fma_f32 v[78:79], v[14:15], v[130:131], v[78:79] op_sel:[1,0,0] op_sel_hi:[1,1,1] neg_lo:[1,0,0] neg_hi:[1,0,0]
    v_cvt_pk_bf16_f32 v8, v72, v73
    v_cvt_pk_bf16_f32 v9, v74, v75
    v_cvt_pk_bf16_f32 v10, v76, v77
    v_cvt_pk_bf16_f32 v11, v78, v79
    buffer_store_dwordx4 v[8:11], v91, s[12:15], 0 offen offset:512 sc1
    s_branch L_p1_done
L_p1_v:
.p2align 3
L_p1loop_7:
    s_waitcnt lgkmcnt(6)
    v_mfma_f32_32x32x16_bf16 v[16:31], v[160:163], v[192:195], v[16:31]
    ds_read_b128 v[176:179], v82 offset:0
    ds_read_b128 v[180:183], v82 offset:4096
    v_mfma_f32_32x32x16_bf16 v[32:47], v[164:167], v[192:195], v[32:47]
    ds_read_b64_tr_b16 v[208:209], v84 offset:24576
    ds_read_b64_tr_b16 v[210:211], v84 offset:25600
    v_mfma_f32_32x32x16_bf16 v[48:63], v[160:163], v[196:199], v[48:63]
    ds_read_b64_tr_b16 v[212:213], v85 offset:24576
    ds_read_b64_tr_b16 v[214:215], v85 offset:25600
    v_mfma_f32_32x32x16_bf16 v[64:79], v[164:167], v[196:199], v[64:79]
    v_xor_b32 v82, v86, v82
    s_waitcnt lgkmcnt(6)
    v_mfma_f32_32x32x16_bf16 v[16:31], v[168:171], v[200:203], v[16:31]
    ds_read_b128 v[184:187], v83 offset:0
    ds_read_b128 v[188:191], v83 offset:4096
    v_mfma_f32_32x32x16_bf16 v[32:47], v[172:175], v[200:203], v[32:47]
    ds_read_b64_tr_b16 v[216:217], v84 offset:28672
    ds_read_b64_tr_b16 v[218:219], v84 offset:29696
    v_mfma_f32_32x32x16_bf16 v[48:63], v[168:171], v[204:207], v[48:63]
    ds_read_b64_tr_b16 v[220:221], v85 offset:28672
    ds_read_b64_tr_b16 v[222:223], v85 offset:29696
    v_mfma_f32_32x32x16_bf16 v[64:79], v[172:175], v[204:207], v[64:79]
    v_xor_b32 v83, v86, v83
    v_xor_b32 v84, v86, v84
    v_xor_b32 v85, v86, v85
    v_xor_b32 v86, 0x10000, v86
    s_waitcnt lgkmcnt(6)
    v_mfma_f32_32x32x16_bf16 v[16:31], v[176:179], v[208:211], v[16:31]
    s_barrier
    ds_read_b128 v[160:163], v80 offset:0
    ds_read_b128 v[164:167], v80 offset:4096
    v_mfma_f32_32x32x16_bf16 v[32:47], v[180:183], v[208:211], v[32:47]
    ds_read_b64_tr_b16 v[192:193], v84 offset:16384
    ds_read_b64_tr_b16 v[194:195], v84 offset:17408
    v_mfma_f32_32x32x16_bf16 v[48:63], v[176:179], v[212:215], v[48:63]
    ds_read_b64_tr_b16 v[196:197], v85 offset:16384
    ds_read_b64_tr_b16 v[198:199], v85 offset:17408
    v_mfma_f32_32x32x16_bf16 v[64:79], v[180:183], v[212:215], v[64:79]
    v_xor_b32 v80, v86, v80
    s_waitcnt lgkmcnt(6)
    v_mfma_f32_32x32x16_bf16 v[16:31], v[184:187], v[216:219], v[16:31]
    ds_read_b128 v[168:171], v81 offset:0
    ds_read_b128 v[172:175], v81 offset:4096
    v_mfma_f32_32x32x16_bf16 v[32:47], v[188:191], v[216:219], v[32:47]
    ds_read_b64_tr_b16 v[200:201], v84 offset:20480
    ds_read_b64_tr_b16 v[202:203], v84 offset:21504
    v_mfma_f32_32x32x16_bf16 v[48:63], v[184:187], v[220:223], v[48:63]
    ds_read_b64_tr_b16 v[204:205], v85 offset:20480
    ds_read_b64_tr_b16 v[206:207], v85 offset:21504
    v_mfma_f32_32x32x16_bf16 v[64:79], v[188:191], v[220:223], v[64:79]
    v_xor_b32 v81, v86, v81
    s_add_u32 s70, s70, 1
    s_cmp_lt_u32 s70, 9
    s_cbranch_scc1 L_p1loop_7
    s_waitcnt lgkmcnt(6)
    v_mfma_f32_32x32x16_bf16 v[16:31], v[160:163], v[192:195], v[16:31]
    ds_read_b128 v[176:179], v82 offset:0
    ds_read_b128 v[180:183], v82 offset:4096
    v_mfma_f32_32x32x16_bf16 v[32:47], v[164:167], v[192:195], v[32:47]
    ds_read_b64_tr_b16 v[208:209], v84 offset:24576
    ds_read_b64_tr_b16 v[210:211], v84 offset:25600
    v_mfma_f32_32x32x16_bf16 v[48:63], v[160:163], v[196:199], v[48:63]
    ds_read_b64_tr_b16 v[212:213], v85 offset:24576
    ds_read_b64_tr_b16 v[214:215], v85 offset:25600
    v_mfma_f32_32x32x16_bf16 v[64:79], v[164:167], v[196:199], v[64:79]
    v_xor_b32 v82, v86, v82
    s_waitcnt lgkmcnt(6)
    v_mfma_f32_32x32x16_bf16 v[16:31], v[168:171], v[200:203], v[16:31]
    ds_read_b128 v[184:187], v83 offset:0
    ds_read_b128 v[188:191], v83 offset:4096
    v_mfma_f32_32x32x16_bf16 v[32:47], v[172:175], v[200:203], v[32:47]
    ds_read_b64_tr_b16 v[216:217], v84 offset:28672
    ds_read_b64_tr_b16 v[218:219], v84 offset:29696
    v_mfma_f32_32x32x16_bf16 v[48:63], v[168:171], v[204:207], v[48:63]
    ds_read_b64_tr_b16 v[220:221], v85 offset:28672
    ds_read_b64_tr_b16 v[222:223], v85 offset:29696
    v_mfma_f32_32x32x16_bf16 v[64:79], v[172:175], v[204:207], v[64:79]
    v_xor_b32 v83, v86, v83
    v_xor_b32 v84, v86, v84
    v_xor_b32 v85, v86, v85
    v_xor_b32 v86, 0x10000, v86
    s_waitcnt lgkmcnt(6)
    v_mfma_f32_32x32x16_bf16 v[16:31], v[176:179], v[208:211], v[16:31]
    v_mfma_f32_32x32x16_bf16 v[32:47], v[180:183], v[208:211], v[32:47]
    v_mfma_f32_32x32x16_bf16 v[48:63], v[176:179], v[212:215], v[48:63]
    v_mfma_f32_32x32x16_bf16 v[64:79], v[180:183], v[212:215], v[64:79]
    s_waitcnt lgkmcnt(0)
    v_mfma_f32_32x32x16_bf16 v[16:31], v[184:187], v[216:219], v[16:31]
    s_barrier
    v_mov_b32 v1, 153600
    ds_read_b64 v[2:3], v1
    ds_read_b32 v12, v92
    ds_read_b32 v13, v92 offset:128
    ds_read_b128 v[96:99], v93 offset:0
    ds_read_b128 v[112:115], v93 offset:512
    ds_read_b128 v[100:103], v93 offset:32
    ds_read_b128 v[116:119], v93 offset:544
    ds_read_b128 v[104:107], v93 offset:64
    ds_read_b128 v[120:123], v93 offset:576
    ds_read_b128 v[108:111], v93 offset:96
    ds_read_b128 v[124:127], v93 offset:608
    ds_read_b128 v[128:131], v93 offset:128
    ds_read_b128 v[144:147], v93 offset:640
    ds_read_b128 v[132:135], v93 offset:160
    ds_read_b128 v[148:151], v93 offset:672
    ds_read_b128 v[136:139], v93 offset:192
    ds_read_b128 v[152:155], v93 offset:704
    ds_read_b128 v[140:143], v93 offset:224
    ds_read_b128 v[156:159], v93 offset:736
    v_mfma_f32_32x32x16_bf16 v[32:47], v[188:191], v[216:219], v[32:47]
    v_mfma_f32_32x32x16_bf16 v[48:63], v[184:187], v[220:223], v[48:63]
    v_mfma_f32_32x32x16_bf16 v[64:79], v[188:191], v[220:223], v[64:79]
    s_waitcnt lgkmcnt(0)
    v_readfirstlane_b32 s32, v2
    v_readfirstlane_b32 s33, v3
    s_nop 5
    v_pk_mul_f32 v[16:17], v[96:97], v[16:17]
    v_pk_mul_f32 v[18:19], v[98:99], v[18:19]
    v_pk_mul_f32 v[20:21], v[100:101], v[20:21]
    v_pk_mul_f32 v[22:23], v[102:103], v[22:23]
    v_pk_fma_f32 v[16:17], v[112:113], v[12:13], v[16:17] op_sel:[0,0,0] op_sel_hi:[1,0,1] neg_lo:[1,0,0] neg_hi:[1,0,0]
    v_pk_fma_f32 v[18:19], v[114:115], v[12:13], v[18:19] op_sel:[0,0,0] op_sel_hi:[1,0,1] neg_lo:[1,0,0] neg_hi:[1,0,0]
    v_pk_fma_f32 v[20:21], v[116:117], v[12:13], v[20:21] op_sel:[0,0,0] op_sel_hi:[1,0,1] neg_lo:[1,0,0] neg_hi:[1,0,0]
    v_pk_fma_f32 v[22:23], v[118:119], v[12:13], v[22:23] op_sel:[0,0,0] op_sel_hi:[1,0,1] neg_lo:[1,0,0] neg_hi:[1,0,0]
    v_cvt_pk_bf16_f32 v4, v16, v17
    v_cvt_pk_bf16_f32 v5, v18, v19
    v_cvt_pk_bf16_f32 v6, v20, v21
    v_cvt_pk_bf16_f32 v7, v22, v23
    buffer_store_dwordx4 v[4:7], v88, s[12:15], 0 offen offset:0 sc1
    v_pk_mul_f32 v[24:25], v[104:105], v[24:25]
    v_pk_mul_f32 v[26:27], v[106:107], v[26:27]
    v_pk_mul_f32 v[28:29], v[108:109], v[28:29]
    v_pk_mul_f32 v[30:31], v[110:111], v[30:31]
    v_pk_fma_f32 v[24:25], v[120:121], v[12:13], v[24:25] op_sel:[0,0,0] op_sel_hi:[1,0,1] neg_lo:[1,0,0] neg_hi:[1,0,0]
    v_pk_fma_f32 v[26:27], v[122:123], v[12:13], v[26:27] op_sel:[0,0,0] op_sel_hi:[1,0,1] neg_lo:[1,0,0] neg_hi:[1,0,0]
    v_pk_fma_f32 v[28:29], v[124:125], v[12:13], v[28:29] op_sel:[0,0,0] op_sel_hi:[1,0,1] neg_lo:[1,0,0] neg_hi:[1,0,0]
    v_pk_fma_f32 v[30:31], v[126:127], v[12:13], v[30:31] op_sel:[0,0,0] op_sel_hi:[1,0,1] neg_lo:[1,0,0] neg_hi:[1,0,0]
    v_cvt_pk_bf16_f32 v8, v24, v25
    v_cvt_pk_bf16_f32 v9, v26, v27
    v_cvt_pk_bf16_f32 v10, v28, v29
    v_cvt_pk_bf16_f32 v11, v30, v31
    buffer_store_dwordx4 v[8:11], v88, s[12:15], 0 offen offset:640 sc1
    v_pk_mul_f32 v[32:33], v[128:129], v[32:33]
    v_pk_mul_f32 v[34:35], v[130:131], v[34:35]
    v_pk_mul_f32 v[36:37], v[132:133], v[36:37]
    v_pk_mul_f32 v[38:39], v[134:135], v[38:39]
    v_pk_fma_f32 v[32:33], v[144:145], v[12:13], v[32:33] op_sel:[0,0,0] op_sel_hi:[1,0,1] neg_lo:[1,0,0] neg_hi:[1,0,0]
    v_pk_fma_f32 v[34:35], v[146:147], v[12:13], v[34:35] op_sel:[0,0,0] op_sel_hi:[1,0,1] neg_lo:[1,0,0] neg_hi:[1,0,0]
    v_pk_fma_f32 v[36:37], v[148:149], v[12:13], v[36:37] op_sel:[0,0,0] op_sel_hi:[1,0,1] neg_lo:[1,0,0] neg_hi:[1,0,0]
    v_pk_fma_f32 v[38:39], v[150:151], v[12:13], v[38:39] op_sel:[0,0,0] op_sel_hi:[1,0,1] neg_lo:[1,0,0] neg_hi:[1,0,0]
    v_cvt_pk_bf16_f32 v4, v32, v33
    v_cvt_pk_bf16_f32 v5, v34, v35
    v_cvt_pk_bf16_f32 v6, v36, v37
    v_cvt_pk_bf16_f32 v7, v38, v39
    buffer_store_dwordx4 v[4:7], v88, s[12:15], 0 offen offset:1280 sc1
    v_pk_mul_f32 v[40:41], v[136:137], v[40:41]
    v_pk_mul_f32 v[42:43], v[138:139], v[42:43]
    v_pk_mul_f32 v[44:45], v[140:141], v[44:45]
    v_pk_mul_f32 v[46:47], v[142:143], v[46:47]
    v_pk_fma_f32 v[40:41], v[152:153], v[12:13], v[40:41] op_sel:[0,0,0] op_sel_hi:[1,0,1] neg_lo:[1,0,0] neg_hi:[1,0,0]
    v_pk_fma_f32 v[42:43], v[154:155], v[12:13], v[42:43] op_sel:[0,0,0] op_sel_hi:[1,0,1] neg_lo:[1,0,0] neg_hi:[1,0,0]
    v_pk_fma_f32 v[44:45], v[156:157], v[12:13], v[44:45] op_sel:[0,0,0] op_sel_hi:[1,0,1] neg_lo:[1,0,0] neg_hi:[1,0,0]
    v_pk_fma_f32 v[46:47], v[158:159], v[12:13], v[46:47] op_sel:[0,0,0] op_sel_hi:[1,0,1] neg_lo:[1,0,0] neg_hi:[1,0,0]
    v_cvt_pk_bf16_f32 v8, v40, v41
    v_cvt_pk_bf16_f32 v9, v42, v43
    v_cvt_pk_bf16_f32 v10, v44, v45
    v_cvt_pk_bf16_f32 v11, v46, v47
    buffer_store_dwordx4 v[8:11], v88, s[12:15], 0 offen offset:1920 sc1
    v_pk_mul_f32 v[48:49], v[96:97], v[48:49]
    v_pk_mul_f32 v[50:51], v[98:99], v[50:51]
    v_pk_mul_f32 v[52:53], v[100:101], v[52:53]
    v_pk_mul_f32 v[54:55], v[102:103], v[54:55]
    v_pk_fma_f32 v[48:49], v[112:113], v[12:13], v[48:49] op_sel:[0,1,0] op_sel_hi:[1,1,1] neg_lo:[1,0,0] neg_hi:[1,0,0]
    v_pk_fma_f32 v[50:51], v[114:115], v[12:13], v[50:51] op_sel:[0,1,0] op_sel_hi:[1,1,1] neg_lo:[1,0,0] neg_hi:[1,0,0]
    v_pk_fma_f32 v[52:53], v[116:117], v[12:13], v[52:53] op_sel:[0,1,0] op_sel_hi:[1,1,1] neg_lo:[1,0,0] neg_hi:[1,0,0]
    v_pk_fma_f32 v[54:55], v[118:119], v[12:13], v[54:55] op_sel:[0,1,0] op_sel_hi:[1,1,1] neg_lo:[1,0,0] neg_hi:[1,0,0]
    v_cvt_pk_bf16_f32 v4, v48, v49
    v_cvt_pk_bf16_f32 v5, v50, v51
    v_cvt_pk_bf16_f32 v6, v52, v53
    v_cvt_pk_bf16_f32 v7, v54, v55
    buffer_store_dwordx4 v[4:7], v89, s[12:15], 0 offen offset:0 sc1
    v_pk_mul_f32 v[56:57], v[104:105], v[56:57]
    v_pk_mul_f32 v[58:59], v[106:107], v[58:59]
    v_pk_mul_f32 v[60:61], v[108:109], v[60:61]
    v_pk_mul_f32 v[62:63], v[110:111], v[62:63]
    v_pk_fma_f32 v[56:57], v[120:121], v[12:13], v[56:57] op_sel:[0,1,0] op_sel_hi:[1,1,1] neg_lo:[1,0,0] neg_hi:[1,0,0]
    v_pk_fma_f32 v[58:59], v[122:123], v[12:13], v[58:59] op_sel:[0,1,0] op_sel_hi:[1,1,1] neg_lo:[1,0,0] neg_hi:[1,0,0]
    v_pk_fma_f32 v[60:61], v[124:125], v[12:13], v[60:61] op_sel:[0,1,0] op_sel_hi:[1,1,1] neg_lo:[1,0,0] neg_hi:[1,0,0]
    v_pk_fma_f32 v[62:63], v[126:127], v[12:13], v[62:63] op_sel:[0,1,0] op_sel_hi:[1,1,1] neg_lo:[1,0,0] neg_hi:[1,0,0]
    v_cvt_pk_bf16_f32 v8, v56, v57
    v_cvt_pk_bf16_f32 v9, v58, v59
    v_cvt_pk_bf16_f32 v10, v60, v61
    v_cvt_pk_bf16_f32 v11, v62, v63
    buffer_store_dwordx4 v[8:11], v89, s[12:15], 0 offen offset:640 sc1
    v_pk_mul_f32 v[64:65], v[128:129], v[64:65]
    v_pk_mul_f32 v[66:67], v[130:131], v[66:67]
    v_pk_mul_f32 v[68:69], v[132:133], v[68:69]
    v_pk_mul_f32 v[70:71], v[134:135], v[70:71]
    v_pk_fma_f32 v[64:65], v[144:145], v[12:13], v[64:65] op_sel:[0,1,0] op_sel_hi:[1,1,1] neg_lo:[1,0,0] neg_hi:[1,0,0]
    v_pk_fma_f32 v[66:67], v[146:147], v[12:13], v[66:67] op_sel:[0,1,0] op_sel_hi:[1,1,1] neg_lo:[1,0,0] neg_hi:[1,0,0]
    v_pk_fma_f32 v[68:69], v[148:149], v[12:13], v[68:69] op_sel:[0,1,0] op_sel_hi:[1,1,1] neg_lo:[1,0,0] neg_hi:[1,0,0]
    v_pk_fma_f32 v[70:71], v[150:151], v[12:13], v[70:71] op_sel:[0,1,0] op_sel_hi:[1,1,1] neg_lo:[1,0,0] neg_hi:[1,0,0]
    v_cvt_pk_bf16_f32 v4, v64, v65
    v_cvt_pk_bf16_f32 v5, v66, v67
    v_cvt_pk_bf16_f32 v6, v68, v69
    v_cvt_pk_bf16_f32 v7, v70, v71
    buffer_store_dwordx4 v[4:7], v89, s[12:15], 0 offen offset:1280 sc1
    v_pk_mul_f32 v[72:73], v[136:137], v[72:73]
    v_pk_mul_f32 v[74:75], v[138:139], v[74:75]
    v_pk_mul_f32 v[76:77], v[140:141], v[76:77]
    v_pk_mul_f32 v[78:79], v[142:143], v[78:79]
    v_pk_fma_f32 v[72:73], v[152:153], v[12:13], v[72:73] op_sel:[0,1,0] op_sel_hi:[1,1,1] neg_lo:[1,0,0] neg_hi:[1,0,0]
    v_pk_fma_f32 v[74:75], v[154:155], v[12:13], v[74:75] op_sel:[0,1,0] op_sel_hi:[1,1,1] neg_lo:[1,0,0] neg_hi:[1,0,0]
    v_pk_fma_f32 v[76:77], v[156:157], v[12:13], v[76:77] op_sel:[0,1,0] op_sel_hi:[1,1,1] neg_lo:[1,0,0] neg_hi:[1,0,0]
    v_pk_fma_f32 v[78:79], v[158:159], v[12:13], v[78:79] op_sel:[0,1,0] op_sel_hi:[1,1,1] neg_lo:[1,0,0] neg_hi:[1,0,0]
    v_cvt_pk_bf16_f32 v8, v72, v73
    v_cvt_pk_bf16_f32 v9, v74, v75
    v_cvt_pk_bf16_f32 v10, v76, v77
    v_cvt_pk_bf16_f32 v11, v78, v79
    buffer_store_dwordx4 v[8:11], v89, s[12:15], 0 offen offset:1920 sc1
L_p1_done:
    s_lshl_b32 s54, s65, 4
    s_add_u32 s54, s54, s64
    s_mul_i32 s54, s54, 128
    s_add_u32 s54, s54, 30441472
    v_mov_b32 v12, s32
    v_mov_b32 v13, s33
    v_mov_b32 v14, 0
    s_waitcnt vmcnt(0)
    s_barrier
    s_cmp_lg_u32 s28, 0
    s_cbranch_scc1 L_nofl_8
    s_mov_b64 exec, 1
    buffer_store_dwordx2 v[12:13], v14, s[12:15], s54 offen sc1
    s_mov_b64 exec, -1
L_nofl_8:
    s_cmp_eq_u32 s28, 0
    s_cbranch_scc1 L_no_rls
    s_mul_i32 s54, s2, 5
    s_add_u32 s54, s54, s28
    s_sub_u32 s54, s54, 1
    s_min_u32 s54, s54, 1279
    s_mov_b32 s93, 16
    s_mov_b32 s94, 8
    s_mov_b32 s95, 4
    s_mov_b32 s27, 0x20000
    s_mov_b32 s92, -1
    s_cmp_lt_u32 s54, 200
    s_cbranch_scc1 L_rl_woL_u_9
    s_cmp_lt_u32 s54, 740
    s_cbranch_scc1 L_rl_w1L_u_9
    s_sub_u32 s54, s54, 740
    s_mul_i32 s55, s54, 6554
    s_lshr_b32 s55, s55, 16
    s_mul_i32 s56, s55, 10
    s_sub_u32 s56, s54, s56
    s_lshl_b32 s96, s55, 5
    s_mov_b32 s24, s46
    s_and_b32 s25, s47, 0xffff
    s_mov_b32 s26, 2211840
    s_mov_b32 s97, 26214400
    s_mov_b32 s98, 276480
    s_cmp_ge_u32 s55, 48
    s_cselect_b32 s93, 4, 16
    s_cselect_b32 s94, 16, 8
    s_cselect_b32 s95, 8, 4
    s_add_u32 s58, s55, 3
    s_cmp_ge_u32 s55, 24
    s_cselect_b32 s58, s58, s55
    s_sub_u32 s59, s55, 24
    s_cmp_ge_u32 s55, 48
    s_cselect_b32 s58, s59, s58
    s_cmp_ge_u32 s55, 51
    s_cselect_b32 s55, s55, s58
    s_branch L_rl_n640L_u_9
L_rl_woL_u_9:
    s_mul_i32 s55, s54, 6554
    s_lshr_b32 s55, s55, 16
    s_mul_i32 s56, s55, 10
    s_sub_u32 s56, s54, s56
    s_mul_i32 s96, s55, 40
    s_mul_i32 s57, s55, 160
    s_sub_u32 s57, s57, 2544
    s_cmp_lt_u32 s55, 16
    s_cselect_b32 s96, s96, s57
    s_cselect_b32 s93, 8, 20
    s_cselect_b32 s94, 20, 0x50
    s_cselect_b32 s95, 4, 40
    s_mov_b32 s24, s40
    s_and_b32 s25, s41, 0xffff
    s_mov_b32 s26, 819200
    s_mov_b32 s97, 22020096
    s_mov_b32 s98, 102400
    s_add_u32 s58, s55, 2
    s_cmp_ge_u32 s55, 8
    s_cselect_b32 s58, s58, s55
    s_sub_u32 s59, s55, 8
    s_cmp_ge_u32 s55, 16
    s_cselect_b32 s58, s59, s58
    s_cmp_ge_u32 s55, 18
    s_cselect_b32 s55, s55, s58
    s_sub_u32 s58, s55, 1
    s_cmp_ge_u32 s55, 10
    s_cselect_b32 s58, s58, s55
    s_cmp_eq_u32 s55, 9
    s_cselect_b32 s58, 18, s58
    s_cmp_eq_u32 s55, 19
    s_cselect_b32 s55, 19, s58
L_rl_n640L_u_9:
    s_mov_b32 s57, 1280
    s_mul_i32 s99, s55, 5120
    s_add_u32 s97, s97, s99
    s_lshl_b32 s58, s56, 2
    s_add_u32 s58, s58, 0
    s_mul_i32 s59, s58, 52
    s_lshr_b32 s59, s59, 8
    s_mul_i32 s88, s59, s98
    s_mul_i32 s59, s59, 5
    s_sub_u32 s58, s58, s59
    s_lshl_b32 s58, s58, 10
    s_add_u32 s88, s88, s58
    s_add_u32 s88, s88, s97
    s_lshl_b32 s58, s56, 2
    s_add_u32 s58, s58, 1
    s_mul_i32 s59, s58, 52
    s_lshr_b32 s59, s59, 8
    s_mul_i32 s89, s59, s98
    s_mul_i32 s59, s59, 5
    s_sub_u32 s58, s58, s59
    s_lshl_b32 s58, s58, 10
    s_add_u32 s89, s89, s58
    s_add_u32 s89, s89, s97
    s_lshl_b32 s58, s56, 2
    s_add_u32 s58, s58, 2
    s_mul_i32 s59, s58, 52
    s_lshr_b32 s59, s59, 8
    s_mul_i32 s90, s59, s98
    s_mul_i32 s59, s59, 5
    s_sub_u32 s58, s58, s59
    s_lshl_b32 s58, s58, 10
    s_add_u32 s90, s90, s58
    s_add_u32 s90, s90, s97
    s_lshl_b32 s58, s56, 2
    s_add_u32 s58, s58, 3
    s_mul_i32 s59, s58, 52
    s_lshr_b32 s59, s59, 8
    s_mul_i32 s91, s59, s98
    s_mul_i32 s59, s59, 5
    s_sub_u32 s58, s58, s59
    s_lshl_b32 s58, s58, 10
    s_add_u32 s91, s91, s58
    s_add_u32 s91, s91, s97
    s_branch L_rl_commonL_u_9
L_rl_w1L_u_9:
    s_sub_u32 s54, s54, 200
    s_mul_i32 s55, s54, 2428
    s_lshr_b32 s55, s55, 16
    s_mul_i32 s56, s55, 27
    s_sub_u32 s56, s54, s56
    s_lshr_b32 s58, s55, 1
    s_mul_i32 s58, s58, 0x50
    s_and_b32 s59, s55, 1
    s_lshl_b32 s59, s59, 5
    s_add_u32 s96, s58, s59
    s_mul_i32 s58, s55, 160
    s_sub_u32 s58, s58, 2496
    s_cmp_lt_u32 s55, 16
    s_cselect_b32 s96, s96, s58
    s_cselect_b32 s93, 16, 4
    s_cselect_b32 s94, 8, 0x50
    s_cselect_b32 s95, 4, 8
    s_mov_b32 s24, s44
    s_and_b32 s25, s45, 0xffff
    s_mov_b32 s26, 2211840
    s_mov_b32 s57, 3456
    s_mul_i32 s99, s55, 7168
    s_add_u32 s97, s99, 23068672
    s_mul_i32 s92, s55, 6912
    s_lshl_b32 s58, s56, 8
    s_add_u32 s92, s92, s58
    s_add_u32 s92, s92, 29360128
    s_lshl_b32 s58, s56, 2
    s_add_u32 s58, s58, 0
    s_mul_i32 s59, s58, 43
    s_lshr_b32 s59, s59, 8
    s_mul_i32 s98, s59, 6
    s_sub_u32 s98, s58, s98
    s_sub_u32 s99, s58, 96
    s_cmp_lt_u32 s58, 96
    s_cselect_b32 s59, s59, s99
    s_cselect_b32 s98, s98, 6
    s_mul_i32 s88, s59, 143360
    s_lshl_b32 s98, s98, 10
    s_add_u32 s88, s88, s98
    s_add_u32 s88, s88, s97
    s_lshl_b32 s58, s56, 2
    s_add_u32 s58, s58, 1
    s_mul_i32 s59, s58, 43
    s_lshr_b32 s59, s59, 8
    s_mul_i32 s98, s59, 6
    s_sub_u32 s98, s58, s98
    s_sub_u32 s99, s58, 96
    s_cmp_lt_u32 s58, 96
    s_cselect_b32 s59, s59, s99
    s_cselect_b32 s98, s98, 6
    s_mul_i32 s89, s59, 143360
    s_lshl_b32 s98, s98, 10
    s_add_u32 s89, s89, s98
    s_add_u32 s89, s89, s97
    s_lshl_b32 s58, s56, 2
    s_add_u32 s58, s58, 2
    s_mul_i32 s59, s58, 43
    s_lshr_b32 s59, s59, 8
    s_mul_i32 s98, s59, 6
    s_sub_u32 s98, s58, s98
    s_sub_u32 s99, s58, 96
    s_cmp_lt_u32 s58, 96
    s_cselect_b32 s59, s59, s99
    s_cselect_b32 s98, s98, 6
    s_mul_i32 s90, s59, 143360
    s_lshl_b32 s98, s98, 10
    s_add_u32 s90, s90, s98
    s_add_u32 s90, s90, s97
    s_lshl_b32 s58, s56, 2
    s_add_u32 s58, s58, 3
    s_mul_i32 s59, s58, 43
    s_lshr_b32 s59, s59, 8
    s_mul_i32 s98, s59, 6
    s_sub_u32 s98, s58, s98
    s_sub_u32 s99, s58, 96
    s_cmp_lt_u32 s58, 96
    s_cselect_b32 s59, s59, s99
    s_cselect_b32 s98, s98, 6
    s_mul_i32 s91, s59, 143360
    s_lshl_b32 s98, s98, 10
    s_add_u32 s91, s91, s98
    s_add_u32 s91, s91, s97
L_rl_commonL_u_9:
    s_mul_i32 s96, s96, s57
    s_lshl_b32 s58, s56, 7
    s_add_u32 s84, s96, s58
    s_mul_i32 s93, s93, s57
    s_mul_i32 s94, s94, s57
    s_add_u32 s85, s84, s94
    s_add_u32 s86, s84, s93
    s_add_u32 s87, s86, s94
    v_lshrrev_b32 v1, 5, v0
    v_mul_u32_u24 v1, s95, v1
    v_bfe_u32 v2, v0, 3, 2
    v_add_u32 v1, v1, v2
    v_mul_u32_u24 v1, s57, v1
    v_and_b32 v2, 7, v0
    v_lshl_add_u32 v157, v2, 4, v1
    v_lshrrev_b32 v1, 2, v0
    v_lshlrev_b32 v1, 7, v1
    v_and_b32 v2, 3, v0
    v_lshl_add_u32 v1, v2, 3, v1
    s_lshl_b32 s58, s28, 12
    s_add_u32 s58, s58, 65536
    v_add_u32 v158, s58, v1
L_no_rls:
    s_lshl_b32 s64, s29, 2
    s_lshr_b32 s54, s30, 3
    s_add_u32 s64, s64, s54
    s_and_b32 s65, s30, 7
    v_lshlrev_b32 v196, 4, v0
    v_lshrrev_b32 v1, 5, v0
    v_and_b32 v2, 31, v0
    v_lshlrev_b32 v3, 15, v1
    v_lshl_add_u32 v197, v2, 4, v3
    v_mov_b32 v152, v196
    s_and_b32 s54, s64, 1
    s_lshl_b32 s54, s54, 3
    v_add_u32 v153, s54, v196
    v_mul_u32_u24 v3, 20, v1
    v_add_lshl_u32 v154, v3, v2, 4
    v_lshl_add_u32 v10, v2, 4, s54
    s_lshl_b32 s54, s28, 2
    s_add_u32 s54, s54, 160768
    v_mov_b32 v155, s54
    v_mov_b32 v156, 0
    v_and_b32 v159, 7, v0
    v_lshlrev_b32 v159, 2, v159
    v_add_u32 v159, 160768, v159
    ds_write_b32 v155, v156
    s_mov_b32 s74, 0x000fffff
    s_mov_b32 s75, 0x000fffff
    s_lshl_b32 s67, s64, 16
    s_lshl_b32 s54, s28, 9
    s_add_u32 s67, s67, s54
    s_add_u32 s67, s67, 2617344
    s_lshl_b32 s54, s28, 10
    s_mul_i32 s69, s64, 81920
    s_add_u32 s69, s69, s54
    s_add_u32 s55, s69, 5228544
    s_cmp_ge_u32 s28, 6
    s_cselect_b32 s56, 2048, 0
    s_sub_u32 s69, s69, s56
    s_add_u32 s69, s69, 5236736
    s_sub_u32 s93, s54, s56
    s_add_u32 s93, s93, 16384
    s_add_u32 s82, s54, 8192
    s_lshr_b32 s56, s64, 1
    s_lshl_b32 s56, s56, 15
    s_add_u32 s68, s56, s54
    s_add_u32 s68, s68, 4714496
    s_mov_b32 s70, 10240
    s_cmp_lt_u32 s28, 4
    s_cselect_b32 s68, s68, s55
    s_cselect_b32 s70, 4096, s70
    s_mov_b32 s71, 0
    s_mov_b32 s66, 0
    s_mov_b32 s72, 22528
    s_mov_b32 s83, 22528
    s_mov_b32 s78, 4294922240
    s_mov_b32 s73, s54
    s_mov_b32 s79, 0x40000000
    s_mov_b32 s95, 0x7f000000
    s_and_b32 s55, s30, 7
    s_mul_i32 s94, s55, 102400
    s_add_u32 s94, s94, 22020096
    s_sub_u32 s55, s94, 67584
    s_add_u32 s8, s12, s55
    s_addc_u32 s9, s13, 0
    s_mov_b32 s10, 159744
    s_lshl_b32 s54, s65, 3
    s_add_u32 s54, s54, s28
    s_lshl_b32 s54, s54, 9
    s_add_u32 s56, s56, s54
    s_add_u32 s80, s56, 2097152
    s_lshl_b32 s57, s64, 16
    s_add_u32 s57, s57, s54
    s_add_u32 s81, s57, 0
    v_cmp_eq_u32 vcc, 20, v2
    v_mov_b32 v3, 0x3f803f80
    s_nop 0
    v_cndmask_b32 v3, 0, v3, vcc
    v_mov_b32 v136, v3
    v_mov_b32 v137, v3
    v_mov_b32 v138, v3
    v_mov_b32 v139, v3
    v_mov_b32 v140, v3
    v_mov_b32 v141, v3
    v_mov_b32 v142, v3
    v_mov_b32 v143, v3
    v_mov_b32 v144, v3
    v_mov_b32 v145, v3
    v_mov_b32 v146, v3
    v_mov_b32 v147, v3
    v_mov_b32 v148, v3
    v_mov_b32 v149, v3
    v_mov_b32 v150, v3
    v_mov_b32 v151, v3
    v_mov_b32 v108, 0
    v_mov_b32 v109, 0
    v_mov_b32 v110, 0
    v_mov_b32 v111, 0
    v_mov_b32 v112, 0
    v_mov_b32 v113, 0
    v_mov_b32 v114, 0
    v_mov_b32 v115, 0
    v_mov_b32 v116, 0
    v_mov_b32 v117, 0
    v_mov_b32 v118, 0
    v_mov_b32 v119, 0
    v_mov_b32 v120, 0
    v_mov_b32 v121, 0
    v_mov_b32 v122, 0
    v_mov_b32 v123, 0
    v_mov_b32 v104, 0
    v_mov_b32 v105, 0
    v_mov_b32 v106, 0
    v_mov_b32 v107, 0
    s_mul_i32 s54, s64, 20
    s_add_u32 s55, s54, 19
    s_lshr_b32 s54, s54, 7
    s_lshr_b32 s55, s55, 7
    s_sub_u32 s55, s55, s54
    s_lshl_b32 s55, s55, 4
    v_and_b32 v188, s55, v0
    v_and_b32 v189, 15, v0
    v_add_u32 v189, v189, v188
    v_mul_u32_u24 v190, 0x50, v1
    v_add3_u32 v189, v189, v190, 64
    v_add_u32 v189, 16, v189
    v_lshlrev_b32 v189, 7, v189
    s_lshl_b32 s56, s65, 1
    v_and_b32 v190, 1, v0
    v_add3_u32 v188, v188, v190, s56
    v_lshlrev_b32 v188, 7, v188
    s_lshl_b32 s54, s54, 11
    s_add_u32 s57, s54, 30441472
    s_cmp_eq_u32 s28, 0
    s_cbranch_scc1 L_nw0_10
    s_lshr_b32 s54, s28, 2
    s_add_u32 s54, s54, s56
    v_and_b32 v188, s55, v0
    v_add_lshl_u32 v188, v188, s54, 7
    s_mov_b32 s62, 0
L_qp_11:
    buffer_load_dwordx2 v[184:185], v188, s[12:15], s57 offen sc1
    s_add_u32 s62, s62, 1
    s_cmp_ge_u32 s62, 200000
    s_cbranch_scc1 L_qpd_12
    s_waitcnt vmcnt(0)
    v_cmp_ne_u64 vcc, s[32:33], v[184:185]
    s_cbranch_vccnz L_qp_11
L_qpd_12:
    buffer_load_dwordx4 v[4:7], v197, s[12:15], s81 offen sc1
    buffer_load_dwordx2 v[8:9], v10, s[12:15], s80 offen sc1
L_nw0_10:
    s_cmp_lg_u32 s28, 0
    s_cbranch_scc1 L_polld_14
    s_mov_b32 s62, 0
L_poll_13:
    buffer_load_dwordx2 v[184:185], v189, s[12:15], s57 offen sc1
    buffer_load_dwordx2 v[186:187], v188, s[12:15], s57 offen sc1
    s_add_u32 s62, s62, 1
    s_waitcnt vmcnt(0)
    v_cmp_ne_u64 vcc, s[32:33], v[184:185]
    v_cmp_ne_u64 s[60:61], s[32:33], v[186:187]
    s_nop 0
    s_or_b64 vcc, vcc, s[60:61]
    s_cbranch_scc0 L_polld_14
    s_cmp_lt_u32 s62, 200000
    s_cbranch_scc1 L_poll_13
L_polld_14:
    s_waitcnt lgkmcnt(0)
    s_barrier
    s_cmp_lg_u32 s28, 0
    s_cbranch_scc1 L_noq
    buffer_load_dwordx4 v[4:7], v197, s[12:15], s81 offen sc1
    buffer_load_dwordx2 v[8:9], v10, s[12:15], s80 offen sc1
L_noq:
    s_add_u32 m0, s73, s71
    s_add_u32 s67, s67, 4096
    buffer_load_dwordx4 v197, s[12:15], s67 offen sc1 lds
    s_add_u32 m0, s82, s71
    s_add_u32 s68, s68, s70
    buffer_load_dwordx4 v196, s[12:15], s68 offen sc1 lds
    s_add_u32 m0, s93, s71
    s_add_u32 s69, s69, 10240
    buffer_load_dwordx4 v196, s[12:15], s69 offen sc1 lds
    s_mov_b32 s71, 22528
    s_lshl_b32 s54, s65, 4
    s_lshl_b32 s55, s28, 1
    s_add_u32 s54, s54, s55
    s_mul_i32 s54, s54, 20480
    s_add_u32 s54, s54, 8388608
    s_lshl_b32 s55, s64, 9
    s_add_u32 s80, s54, s55
    s_lshr_b32 s55, s64, 4
    s_lshl_b32 s56, s55, 11
    s_add_u32 s80, s80, s56
    s_lshl_b32 s55, s55, 13
    s_add_u32 s54, s54, s55
    s_lshr_b32 s55, s64, 3
    s_lshl_b32 s55, s55, 10
    s_add_u32 s54, s54, s55
    s_bfe_u32 s55, s64, 0x20001
    s_lshl_b32 s55, s55, 7
    s_add_u32 s54, s54, s55
    s_and_b32 s55, s64, 1
    s_lshl_b32 s55, s55, 9
    s_add_u32 s54, s54, s55
    s_add_u32 s81, s54, 8192
    v_bfe_u32 v3, v0, 4, 1
    v_mul_u32_u24 v3, 20480, v3
    v_and_b32 v10, 15, v0
    v_lshl_add_u32 v11, v10, 4, v3
    v_lshl_add_u32 v166, v10, 3, v3
    v_lshrrev_b32 v10, 5, v0
    v_lshl_add_u32 v165, v10, 8, v11
    s_waitcnt vmcnt(0)
    s_add_u32 m0, s73, s71
    s_add_u32 s67, s67, 4096
    buffer_load_dwordx4 v197, s[12:15], s67 offen sc1 lds
    s_add_u32 m0, s82, s71
    s_add_u32 s68, s68, s70
    buffer_load_dwordx4 v196, s[12:15], s68 offen sc1 lds
    s_add_u32 m0, s93, s71
    s_add_u32 s69, s69, 10240
    buffer_load_dwordx4 v196, s[12:15], s69 offen sc1 lds
    s_mov_b32 s71, 45056
    s_barrier
    ds_read_b128 v[124:127], v152 offset:0
    ds_read_b128 v[128:131], v152 offset:1024
    ds_read_b64 v[132:133], v153 offset:8192
    v_mov_b32 v184, 0xff800000
    s_waitcnt lgkmcnt(0)
    v_mfma_f32_32x32x16_bf16 v[28:43], v[124:127], v[4:7], 0
    v_mfma_f32_32x32x16_bf16 v[44:59], v[128:131], v[4:7], 0
    s_nop 9
    v_mfma_f32_32x32x4_2b_bf16 v[28:59], v[132:133], v[8:9], v[28:59]
    ds_read_b128 v[124:127], v152 offset:2048
    ds_read_b128 v[128:131], v152 offset:3072
    ds_read_b64 v[132:133], v153 offset:9216
    buffer_load_dwordx4 v[160:163], v196, s[12:15], s95 offen sc1
    s_add_u32 s95, s95, 1024
    s_sub_u32 s54, s28, 1
    s_cmp_ge_u32 s54, 5
    s_cbranch_scc1 L_rlsk_15
    s_lshl_b32 s54, s28, 12
    s_add_u32 m0, s54, 65536
    s_nop 0
    buffer_load_dwordx4 v157, s[24:27], s84 offen lds
    s_add_u32 m0, m0, 1024
    s_nop 0
    buffer_load_dwordx4 v157, s[24:27], s85 offen lds
    s_add_u32 m0, m0, 1024
    s_nop 0
    buffer_load_dwordx4 v157, s[24:27], s86 offen lds
    s_add_u32 m0, m0, 1024
    s_nop 0
    buffer_load_dwordx4 v157, s[24:27], s87 offen lds
    s_branch L_rlw_16
L_rlsk_15:
    s_min_u32 m0, s79, 159744
    s_add_u32 s79, s79, 8192
    buffer_load_dwordx4 v196, s[8:11], m0 offen sc1 lds
    s_min_u32 m0, s79, 159744
    s_add_u32 s79, s79, 8192
    buffer_load_dwordx4 v196, s[8:11], m0 offen sc1 lds
    s_min_u32 m0, s79, 159744
    s_add_u32 s79, s79, 8192
    buffer_load_dwordx4 v196, s[8:11], m0 offen sc1 lds
    buffer_load_dwordx4 v[160:163], v196, s[12:15], s95 offen sc1
    s_add_u32 s95, s95, 1024
L_rlw_16:
    s_nop 9
    s_nop 3
    v_max3_f32 v184, v28, v29, v184
    v_max3_f32 v184, v30, v31, v184
    v_max3_f32 v184, v32, v33, v184
    v_max3_f32 v184, v34, v35, v184
    v_max3_f32 v184, v36, v37, v184
    v_max3_f32 v184, v38, v39, v184
    v_max3_f32 v184, v40, v41, v184
    v_max3_f32 v184, v42, v43, v184
    v_max3_f32 v184, v44, v45, v184
    v_max3_f32 v184, v46, v47, v184
    v_max3_f32 v184, v48, v49, v184
    v_max3_f32 v184, v50, v51, v184
    v_max3_f32 v184, v52, v53, v184
    v_max3_f32 v184, v54, v55, v184
    v_max3_f32 v184, v56, v57, v184
    v_max3_f32 v184, v58, v59, v184
    v_mov_b32 v188, v184
    s_nop 1
    v_permlane32_swap_b32 v184, v188
    s_nop 0
    v_max_f32 v184, v184, v188
    v_sub_f32 v12, 0, v184
    v_sub_f32 v13, 0, v184
    v_sub_f32 v14, 0, v184
    v_sub_f32 v15, 0, v184
    v_sub_f32 v16, 0, v184
    v_sub_f32 v17, 0, v184
    v_sub_f32 v18, 0, v184
    v_sub_f32 v19, 0, v184
    v_sub_f32 v20, 0, v184
    v_sub_f32 v21, 0, v184
    v_sub_f32 v22, 0, v184
    v_sub_f32 v23, 0, v184
    v_sub_f32 v24, 0, v184
    v_sub_f32 v25, 0, v184
    v_sub_f32 v26, 0, v184
    v_sub_f32 v27, 0, v184
    v_sub_f32 v28, v28, v184
    v_sub_f32 v29, v29, v184
    v_sub_f32 v30, v30, v184
    v_sub_f32 v31, v31, v184
    v_sub_f32 v32, v32, v184
    v_sub_f32 v33, v33, v184
    v_sub_f32 v34, v34, v184
    v_sub_f32 v35, v35, v184
    v_sub_f32 v36, v36, v184
    v_sub_f32 v37, v37, v184
    v_sub_f32 v38, v38, v184
    v_sub_f32 v39, v39, v184
    v_sub_f32 v40, v40, v184
    v_sub_f32 v41, v41, v184
    v_sub_f32 v42, v42, v184
    v_sub_f32 v43, v43, v184
    v_sub_f32 v44, v44, v184
    v_sub_f32 v45, v45, v184
    v_sub_f32 v46, v46, v184
    v_sub_f32 v47, v47, v184
    v_sub_f32 v48, v48, v184
    v_sub_f32 v49, v49, v184
    v_sub_f32 v50, v50, v184
    v_sub_f32 v51, v51, v184
    v_sub_f32 v52, v52, v184
    v_sub_f32 v53, v53, v184
    v_sub_f32 v54, v54, v184
    v_sub_f32 v55, v55, v184
    v_sub_f32 v56, v56, v184
    v_sub_f32 v57, v57, v184
    v_sub_f32 v58, v58, v184
    v_sub_f32 v59, v59, v184
    s_cmp_ge_u32 s28, 4
    s_cbranch_scc1 L_att_young
.p2align 3
L_att_old:
    s_waitcnt lgkmcnt(0)
    v_mfma_f32_32x32x16_bf16 v[60:75], v[124:127], v[4:7], v[12:27]
    v_exp_f32 v28, v28
    v_exp_f32 v29, v29
    v_exp_f32 v30, v30
    v_exp_f32 v31, v31
    v_mfma_f32_32x32x16_bf16 v[108:123], v[148:151], v[104:107], v[108:123]
    s_mov_b64 exec, s[74:75]
    ds_read_b128 v[136:139], v154 offset:12288
    ds_read_b128 v[140:143], v154 offset:12928
    ds_read_b128 v[144:147], v154 offset:13568
    ds_read_b128 v[148:151], v154 offset:14208
    s_mov_b64 exec, -1
    v_exp_f32 v32, v32
    v_exp_f32 v33, v33
    v_exp_f32 v34, v34
    v_exp_f32 v35, v35
    v_mfma_f32_32x32x16_bf16 v[76:91], v[128:131], v[4:7], v[12:27]
    ds_read_b128 v[124:127], v152 offset:4096
    v_cvt_pk_bf16_f32 v92, v28, v29
    v_cvt_pk_bf16_f32 v93, v30, v31
    v_cvt_pk_bf16_f32 v94, v32, v33
    v_cvt_pk_bf16_f32 v95, v34, v35
    v_exp_f32 v36, v36
    v_exp_f32 v37, v37
    v_exp_f32 v38, v38
    v_exp_f32 v39, v39
    ds_read_b128 v[128:131], v152 offset:5120
    v_add_u32 v156, 1, v156
    s_waitcnt vmcnt(5)
    ds_write_b32 v155, v156
    s_waitcnt lgkmcnt(3)
    v_mfma_f32_32x32x16_bf16 v[108:123], v[136:139], v[92:95], v[108:123]
    v_exp_f32 v40, v40
    v_exp_f32 v41, v41
    v_exp_f32 v42, v42
    v_exp_f32 v43, v43
    v_cvt_pk_bf16_f32 v96, v36, v37
    v_cvt_pk_bf16_f32 v97, v38, v39
    v_mfma_f32_32x32x4_2b_bf16 v[60:91], v[132:133], v[8:9], v[60:91]
    v_cvt_pk_bf16_f32 v98, v40, v41
    v_cvt_pk_bf16_f32 v99, v42, v43
    ds_read_b64 v[132:133], v153 offset:10240
    v_exp_f32 v44, v44
    v_exp_f32 v45, v45
    v_exp_f32 v46, v46
    v_exp_f32 v47, v47
    v_exp_f32 v48, v48
    v_exp_f32 v49, v49
    v_exp_f32 v50, v50
    v_exp_f32 v51, v51
    v_cvt_pk_bf16_f32 v100, v44, v45
    v_cvt_pk_bf16_f32 v101, v46, v47
    v_mfma_f32_32x32x16_bf16 v[108:123], v[140:143], v[96:99], v[108:123]
    v_cvt_pk_bf16_f32 v102, v48, v49
    v_cvt_pk_bf16_f32 v103, v50, v51
    v_exp_f32 v52, v52
    v_exp_f32 v53, v53
    v_exp_f32 v54, v54
    v_exp_f32 v55, v55
    v_exp_f32 v56, v56
    v_mfma_f32_32x32x16_bf16 v[108:123], v[144:147], v[100:103], v[108:123]
    v_exp_f32 v57, v57
    v_exp_f32 v58, v58
    v_exp_f32 v59, v59
    v_cvt_pk_bf16_f32 v104, v52, v53
    v_cvt_pk_bf16_f32 v105, v54, v55
    v_cvt_pk_bf16_f32 v106, v56, v57
    v_cvt_pk_bf16_f32 v107, v58, v59
    s_waitcnt lgkmcnt(0)
    v_mfma_f32_32x32x16_bf16 v[28:43], v[124:127], v[4:7], v[12:27]
    v_exp_f32 v60, v60
    v_exp_f32 v61, v61
    v_exp_f32 v62, v62
    v_exp_f32 v63, v63
    v_mfma_f32_32x32x16_bf16 v[108:123], v[148:151], v[104:107], v[108:123]
    s_mov_b64 exec, s[74:75]
    ds_read_b128 v[136:139], v154 offset:14848
    ds_read_b128 v[140:143], v154 offset:15488
    ds_read_b128 v[144:147], v154 offset:16128
    ds_read_b128 v[148:151], v154 offset:16768
    s_mov_b64 exec, -1
    v_exp_f32 v64, v64
    v_exp_f32 v65, v65
    v_exp_f32 v66, v66
    v_exp_f32 v67, v67
    v_mfma_f32_32x32x16_bf16 v[44:59], v[128:131], v[4:7], v[12:27]
    ds_read_b128 v[124:127], v152 offset:6144
    v_cvt_pk_bf16_f32 v92, v60, v61
    v_cvt_pk_bf16_f32 v93, v62, v63
    v_cvt_pk_bf16_f32 v94, v64, v65
    v_cvt_pk_bf16_f32 v95, v66, v67
    v_exp_f32 v68, v68
    v_exp_f32 v69, v69
    v_exp_f32 v70, v70
    v_exp_f32 v71, v71
    ds_read_b128 v[128:131], v152 offset:7168
    s_waitcnt lgkmcnt(2)
    v_mfma_f32_32x32x16_bf16 v[108:123], v[136:139], v[92:95], v[108:123]
    v_exp_f32 v72, v72
    v_exp_f32 v73, v73
    v_exp_f32 v74, v74
    v_exp_f32 v75, v75
    v_cvt_pk_bf16_f32 v96, v68, v69
    v_cvt_pk_bf16_f32 v97, v70, v71
    v_mfma_f32_32x32x4_2b_bf16 v[28:59], v[132:133], v[8:9], v[28:59]
    v_cvt_pk_bf16_f32 v98, v72, v73
    v_cvt_pk_bf16_f32 v99, v74, v75
    ds_read_b64 v[132:133], v153 offset:11264
    v_exp_f32 v76, v76
    v_exp_f32 v77, v77
    v_exp_f32 v78, v78
    v_exp_f32 v79, v79
    v_exp_f32 v80, v80
    v_exp_f32 v81, v81
    v_exp_f32 v82, v82
    v_exp_f32 v83, v83
    v_cvt_pk_bf16_f32 v100, v76, v77
    v_cvt_pk_bf16_f32 v101, v78, v79
    ds_read_b32 v164, v159
    v_mfma_f32_32x32x16_bf16 v[108:123], v[140:143], v[96:99], v[108:123]
    v_cvt_pk_bf16_f32 v102, v80, v81
    v_cvt_pk_bf16_f32 v103, v82, v83
    v_exp_f32 v84, v84
    v_exp_f32 v85, v85
    v_exp_f32 v86, v86
    v_exp_f32 v87, v87
    v_exp_f32 v88, v88
    s_waitcnt lgkmcnt(0)
    v_cmp_lt_u32 vcc, v164, v156
    s_cbranch_vccnz L_late_17
L_go_18:
    s_call_b64 s[76:77], L_att_side
    v_mfma_f32_32x32x16_bf16 v[108:123], v[144:147], v[100:103], v[108:123]
    v_exp_f32 v89, v89
    v_exp_f32 v90, v90
    v_exp_f32 v91, v91
    v_cvt_pk_bf16_f32 v104, v84, v85
    v_cvt_pk_bf16_f32 v105, v86, v87
    v_cvt_pk_bf16_f32 v106, v88, v89
    v_cvt_pk_bf16_f32 v107, v90, v91
    v_add_u32 v152, s72, v152
    v_add_u32 v153, s72, v153
    s_waitcnt lgkmcnt(0)
    v_mfma_f32_32x32x16_bf16 v[60:75], v[124:127], v[4:7], v[12:27]
    v_exp_f32 v28, v28
    v_exp_f32 v29, v29
    v_exp_f32 v30, v30
    v_exp_f32 v31, v31
    s_add_u32 m0, s73, s71
    s_add_u32 s67, s67, 4096
    buffer_load_dwordx4 v197, s[12:15], s67 offen sc1 lds
    v_mfma_f32_32x32x16_bf16 v[108:123], v[148:151], v[104:107], v[108:123]
    s_mov_b64 exec, s[74:75]
    ds_read_b128 v[136:139], v154 offset:17408
    ds_read_b128 v[140:143], v154 offset:18048
    ds_read_b128 v[144:147], v154 offset:18688
    ds_read_b128 v[148:151], v154 offset:19328
    s_mov_b64 exec, -1
    v_exp_f32 v32, v32
    v_exp_f32 v33, v33
    v_exp_f32 v34, v34
    v_exp_f32 v35, v35
    v_mfma_f32_32x32x16_bf16 v[76:91], v[128:131], v[4:7], v[12:27]
    ds_read_b128 v[124:127], v152 offset:0
    v_cvt_pk_bf16_f32 v92, v28, v29
    v_cvt_pk_bf16_f32 v93, v30, v31
    v_cvt_pk_bf16_f32 v94, v32, v33
    v_cvt_pk_bf16_f32 v95, v34, v35
    s_add_u32 m0, s82, s71
    s_add_u32 s68, s68, s70
    buffer_load_dwordx4 v196, s[12:15], s68 offen sc1 lds
    v_exp_f32 v36, v36
    v_exp_f32 v37, v37
    v_exp_f32 v38, v38
    v_exp_f32 v39, v39
    ds_read_b128 v[128:131], v152 offset:1024
    s_waitcnt lgkmcnt(2)
    v_mfma_f32_32x32x16_bf16 v[108:123], v[136:139], v[92:95], v[108:123]
    v_exp_f32 v40, v40
    v_exp_f32 v41, v41
    v_exp_f32 v42, v42
    v_exp_f32 v43, v43
    v_cvt_pk_bf16_f32 v96, v36, v37
    v_cvt_pk_bf16_f32 v97, v38, v39
    s_add_u32 m0, s93, s71
    s_add_u32 s69, s69, 10240
    buffer_load_dwordx4 v196, s[12:15], s69 offen sc1 lds
    v_mfma_f32_32x32x4_2b_bf16 v[60:91], v[132:133], v[8:9], v[60:91]
    v_cvt_pk_bf16_f32 v98, v40, v41
    v_cvt_pk_bf16_f32 v99, v42, v43
    ds_read_b64 v[132:133], v153 offset:8192
    v_exp_f32 v44, v44
    v_exp_f32 v45, v45
    v_exp_f32 v46, v46
    v_exp_f32 v47, v47
    v_exp_f32 v48, v48
    v_exp_f32 v49, v49
    v_exp_f32 v50, v50
    v_exp_f32 v51, v51
    v_cvt_pk_bf16_f32 v100, v44, v45
    v_cvt_pk_bf16_f32 v101, v46, v47
    s_min_u32 m0, s79, 159744
    s_add_u32 s79, s79, 8192
    buffer_load_dwordx4 v196, s[8:11], m0 offen sc1 lds
    v_mfma_f32_32x32x16_bf16 v[108:123], v[140:143], v[96:99], v[108:123]
    v_cvt_pk_bf16_f32 v102, v48, v49
    v_cvt_pk_bf16_f32 v103, v50, v51
    v_exp_f32 v52, v52
    v_exp_f32 v53, v53
    v_exp_f32 v54, v54
    v_exp_f32 v55, v55
    v_exp_f32 v56, v56
    buffer_load_dwordx4 v[160:163], v196, s[12:15], s95 offen sc1
    s_add_u32 s95, s95, 1024
    v_mfma_f32_32x32x16_bf16 v[108:123], v[144:147], v[100:103], v[108:123]
    v_exp_f32 v57, v57
    v_exp_f32 v58, v58
    v_exp_f32 v59, v59
    v_cvt_pk_bf16_f32 v104, v52, v53
    v_cvt_pk_bf16_f32 v105, v54, v55
    v_cvt_pk_bf16_f32 v106, v56, v57
    v_cvt_pk_bf16_f32 v107, v58, v59
    s_min_u32 m0, s79, 159744
    s_add_u32 s79, s79, 8192
    buffer_load_dwordx4 v196, s[8:11], m0 offen sc1 lds
    s_waitcnt lgkmcnt(0)
    v_mfma_f32_32x32x16_bf16 v[28:43], v[124:127], v[4:7], v[12:27]
    v_exp_f32 v60, v60
    v_exp_f32 v61, v61
    v_exp_f32 v62, v62
    v_exp_f32 v63, v63
    v_mfma_f32_32x32x16_bf16 v[108:123], v[148:151], v[104:107], v[108:123]
    s_mov_b64 exec, s[74:75]
    ds_read_b128 v[136:139], v154 offset:19968
    ds_read_b128 v[140:143], v154 offset:20608
    ds_read_b128 v[144:147], v154 offset:21248
    ds_read_b128 v[148:151], v154 offset:21888
    s_mov_b64 exec, -1
    v_exp_f32 v64, v64
    v_exp_f32 v65, v65
    v_exp_f32 v66, v66
    v_exp_f32 v67, v67
    buffer_load_dwordx4 v[160:163], v196, s[12:15], s95 offen sc1
    s_add_u32 s95, s95, 1024
    v_mfma_f32_32x32x16_bf16 v[44:59], v[128:131], v[4:7], v[12:27]
    ds_read_b128 v[124:127], v152 offset:2048
    v_cvt_pk_bf16_f32 v92, v60, v61
    v_cvt_pk_bf16_f32 v93, v62, v63
    v_cvt_pk_bf16_f32 v94, v64, v65
    v_cvt_pk_bf16_f32 v95, v66, v67
    v_exp_f32 v68, v68
    v_exp_f32 v69, v69
    v_exp_f32 v70, v70
    v_exp_f32 v71, v71
    ds_read_b128 v[128:131], v152 offset:3072
    s_min_u32 m0, s79, 159744
    s_add_u32 s79, s79, 8192
    buffer_load_dwordx4 v196, s[8:11], m0 offen sc1 lds
    s_waitcnt lgkmcnt(2)
    v_mfma_f32_32x32x16_bf16 v[108:123], v[136:139], v[92:95], v[108:123]
    v_exp_f32 v72, v72
    v_exp_f32 v73, v73
    v_exp_f32 v74, v74
    v_exp_f32 v75, v75
    v_cvt_pk_bf16_f32 v96, v68, v69
    v_cvt_pk_bf16_f32 v97, v70, v71
    v_mfma_f32_32x32x4_2b_bf16 v[28:59], v[132:133], v[8:9], v[28:59]
    v_cvt_pk_bf16_f32 v98, v72, v73
    v_cvt_pk_bf16_f32 v99, v74, v75
    ds_read_b64 v[132:133], v153 offset:9216
    v_exp_f32 v76, v76
    v_exp_f32 v77, v77
    v_exp_f32 v78, v78
    v_exp_f32 v79, v79
    v_exp_f32 v80, v80
    v_exp_f32 v81, v81
    v_exp_f32 v82, v82
    v_exp_f32 v83, v83
    v_cvt_pk_bf16_f32 v100, v76, v77
    v_cvt_pk_bf16_f32 v101, v78, v79
    v_mfma_f32_32x32x16_bf16 v[108:123], v[140:143], v[96:99], v[108:123]
    v_cvt_pk_bf16_f32 v102, v80, v81
    v_cvt_pk_bf16_f32 v103, v82, v83
    v_exp_f32 v84, v84
    v_exp_f32 v85, v85
    s_cmp_lg_u32 s66, 0
    s_cbranch_scc1 L_nf_19
    s_call_b64 s[76:77], L_as_fin
L_nf_19:
    v_exp_f32 v86, v86
    v_exp_f32 v87, v87
    v_exp_f32 v88, v88
    v_mfma_f32_32x32x16_bf16 v[108:123], v[144:147], v[100:103], v[108:123]
    v_exp_f32 v89, v89
    v_exp_f32 v90, v90
    v_exp_f32 v91, v91
    v_cvt_pk_bf16_f32 v104, v84, v85
    v_cvt_pk_bf16_f32 v105, v86, v87
    v_cvt_pk_bf16_f32 v106, v88, v89
    v_cvt_pk_bf16_f32 v107, v90, v91
    v_add_u32 v154, s72, v154
    s_add_u32 s66, s66, 1
    s_add_u32 s71, s71, s78
    s_mov_b32 s54, s72
    s_mov_b32 s72, s83
    s_mov_b32 s83, s78
    s_mov_b32 s78, s54
    s_cmp_lt_u32 s66, 8
    s_cbranch_scc1 L_att_old
    s_branch L_att_done
.p2align 3
L_att_young:
    s_setprio 1
    s_waitcnt lgkmcnt(0)
    v_mfma_f32_32x32x16_bf16 v[60:75], v[124:127], v[4:7], v[12:27]
    v_exp_f32 v28, v28
    v_exp_f32 v29, v29
    v_exp_f32 v30, v30
    v_exp_f32 v31, v31
    v_mfma_f32_32x32x16_bf16 v[108:123], v[148:151], v[104:107], v[108:123]
    s_mov_b64 exec, s[74:75]
    ds_read_b128 v[136:139], v154 offset:12288
    ds_read_b128 v[140:143], v154 offset:12928
    ds_read_b128 v[144:147], v154 offset:13568
    ds_read_b128 v[148:151], v154 offset:14208
    s_mov_b64 exec, -1
    v_exp_f32 v32, v32
    v_exp_f32 v33, v33
    v_exp_f32 v34, v34
    v_exp_f32 v35, v35
    v_mfma_f32_32x32x16_bf16 v[76:91], v[128:131], v[4:7], v[12:27]
    ds_read_b128 v[124:127], v152 offset:4096
    v_cvt_pk_bf16_f32 v92, v28, v29
    v_cvt_pk_bf16_f32 v93, v30, v31
    v_cvt_pk_bf16_f32 v94, v32, v33
    v_cvt_pk_bf16_f32 v95, v34, v35
    v_exp_f32 v36, v36
    v_exp_f32 v37, v37
    v_exp_f32 v38, v38
    v_exp_f32 v39, v39
    ds_read_b128 v[128:131], v152 offset:5120
    v_add_u32 v156, 1, v156
    s_waitcnt vmcnt(5)
    ds_write_b32 v155, v156
    s_waitcnt lgkmcnt(3)
    v_mfma_f32_32x32x16_bf16 v[108:123], v[136:139], v[92:95], v[108:123]
    v_exp_f32 v40, v40
    v_exp_f32 v41, v41
    v_exp_f32 v42, v42
    v_exp_f32 v43, v43
    v_cvt_pk_bf16_f32 v96, v36, v37
    v_cvt_pk_bf16_f32 v97, v38, v39
    v_mfma_f32_32x32x4_2b_bf16 v[60:91], v[132:133], v[8:9], v[60:91]
    v_cvt_pk_bf16_f32 v98, v40, v41
    v_cvt_pk_bf16_f32 v99, v42, v43
    ds_read_b64 v[132:133], v153 offset:10240
    v_exp_f32 v44, v44
    v_exp_f32 v45, v45
    v_exp_f32 v46, v46
    v_exp_f32 v47, v47
    v_exp_f32 v48, v48
    v_exp_f32 v49, v49
    v_exp_f32 v50, v50
    v_exp_f32 v51, v51
    v_cvt_pk_bf16_f32 v100, v44, v45
    v_cvt_pk_bf16_f32 v101, v46, v47
    s_setprio 0
    v_mfma_f32_32x32x16_bf16 v[108:123], v[140:143], v[96:99], v[108:123]
    v_cvt_pk_bf16_f32 v102, v48, v49
    v_cvt_pk_bf16_f32 v103, v50, v51
    v_exp_f32 v52, v52
    v_exp_f32 v53, v53
    v_exp_f32 v54, v54
    v_exp_f32 v55, v55
    v_exp_f32 v56, v56
    v_mfma_f32_32x32x16_bf16 v[108:123], v[144:147], v[100:103], v[108:123]
    v_exp_f32 v57, v57
    v_exp_f32 v58, v58
    v_exp_f32 v59, v59
    v_cvt_pk_bf16_f32 v104, v52, v53
    v_cvt_pk_bf16_f32 v105, v54, v55
    v_cvt_pk_bf16_f32 v106, v56, v57
    v_cvt_pk_bf16_f32 v107, v58, v59
    s_setprio 1
    s_waitcnt lgkmcnt(0)
    v_mfma_f32_32x32x16_bf16 v[28:43], v[124:127], v[4:7], v[12:27]
    v_exp_f32 v60, v60
    v_exp_f32 v61, v61
    v_exp_f32 v62, v62
    v_exp_f32 v63, v63
    v_mfma_f32_32x32x16_bf16 v[108:123], v[148:151], v[104:107], v[108:123]
    s_mov_b64 exec, s[74:75]
    ds_read_b128 v[136:139], v154 offset:14848
    ds_read_b128 v[140:143], v154 offset:15488
    ds_read_b128 v[144:147], v154 offset:16128
    ds_read_b128 v[148:151], v154 offset:16768
    s_mov_b64 exec, -1
    v_exp_f32 v64, v64
    v_exp_f32 v65, v65
    v_exp_f32 v66, v66
    v_exp_f32 v67, v67
    v_mfma_f32_32x32x16_bf16 v[44:59], v[128:131], v[4:7], v[12:27]
    ds_read_b128 v[124:127], v152 offset:6144
    v_cvt_pk_bf16_f32 v92, v60, v61
    v_cvt_pk_bf16_f32 v93, v62, v63
    v_cvt_pk_bf16_f32 v94, v64, v65
    v_cvt_pk_bf16_f32 v95, v66, v67
    v_exp_f32 v68, v68
    v_exp_f32 v69, v69
    v_exp_f32 v70, v70
    v_exp_f32 v71, v71
    ds_read_b128 v[128:131], v152 offset:7168
    s_waitcnt lgkmcnt(2)
    v_mfma_f32_32x32x16_bf16 v[108:123], v[136:139], v[92:95], v[108:123]
    v_exp_f32 v72, v72
    v_exp_f32 v73, v73
    v_exp_f32 v74, v74
    v_exp_f32 v75, v75
    v_cvt_pk_bf16_f32 v96, v68, v69
    v_cvt_pk_bf16_f32 v97, v70, v71
    v_mfma_f32_32x32x4_2b_bf16 v[28:59], v[132:133], v[8:9], v[28:59]
    v_cvt_pk_bf16_f32 v98, v72, v73
    v_cvt_pk_bf16_f32 v99, v74, v75
    ds_read_b64 v[132:133], v153 offset:11264
    v_exp_f32 v76, v76
    v_exp_f32 v77, v77
    v_exp_f32 v78, v78
    v_exp_f32 v79, v79
    v_exp_f32 v80, v80
    v_exp_f32 v81, v81
    v_exp_f32 v82, v82
    v_exp_f32 v83, v83
    v_cvt_pk_bf16_f32 v100, v76, v77
    v_cvt_pk_bf16_f32 v101, v78, v79
    ds_read_b32 v164, v159
    s_setprio 0
    v_mfma_f32_32x32x16_bf16 v[108:123], v[140:143], v[96:99], v[108:123]
    v_cvt_pk_bf16_f32 v102, v80, v81
    v_cvt_pk_bf16_f32 v103, v82, v83
    v_exp_f32 v84, v84
    v_exp_f32 v85, v85
    v_exp_f32 v86, v86
    v_exp_f32 v87, v87
    v_exp_f32 v88, v88
    s_waitcnt lgkmcnt(0)
    v_cmp_lt_u32 vcc, v164, v156
    s_cbranch_vccnz L_late_20
L_go_21:
    s_call_b64 s[76:77], L_att_side
    v_mfma_f32_32x32x16_bf16 v[108:123], v[144:147], v[100:103], v[108:123]
    v_exp_f32 v89, v89
    v_exp_f32 v90, v90
    v_exp_f32 v91, v91
    v_cvt_pk_bf16_f32 v104, v84, v85
    v_cvt_pk_bf16_f32 v105, v86, v87
    v_cvt_pk_bf16_f32 v106, v88, v89
    v_cvt_pk_bf16_f32 v107, v90, v91
    v_add_u32 v152, s72, v152
    v_add_u32 v153, s72, v153
    s_setprio 1
    s_waitcnt lgkmcnt(0)
    v_mfma_f32_32x32x16_bf16 v[60:75], v[124:127], v[4:7], v[12:27]
    v_exp_f32 v28, v28
    v_exp_f32 v29, v29
    v_exp_f32 v30, v30
    v_exp_f32 v31, v31
    s_add_u32 m0, s73, s71
    s_add_u32 s67, s67, 4096
    buffer_load_dwordx4 v197, s[12:15], s67 offen sc1 lds
    v_mfma_f32_32x32x16_bf16 v[108:123], v[148:151], v[104:107], v[108:123]
    s_mov_b64 exec, s[74:75]
    ds_read_b128 v[136:139], v154 offset:17408
    ds_read_b128 v[140:143], v154 offset:18048
    ds_read_b128 v[144:147], v154 offset:18688
    ds_read_b128 v[148:151], v154 offset:19328
    s_mov_b64 exec, -1
    v_exp_f32 v32, v32
    v_exp_f32 v33, v33
    v_exp_f32 v34, v34
    v_exp_f32 v35, v35
    v_mfma_f32_32x32x16_bf16 v[76:91], v[128:131], v[4:7], v[12:27]
    ds_read_b128 v[124:127], v152 offset:0
    v_cvt_pk_bf16_f32 v92, v28, v29
    v_cvt_pk_bf16_f32 v93, v30, v31
    v_cvt_pk_bf16_f32 v94, v32, v33
    v_cvt_pk_bf16_f32 v95, v34, v35
    s_add_u32 m0, s82, s71
    s_add_u32 s68, s68, s70
    buffer_load_dwordx4 v196, s[12:15], s68 offen sc1 lds
    v_exp_f32 v36, v36
    v_exp_f32 v37, v37
    v_exp_f32 v38, v38
    v_exp_f32 v39, v39
    ds_read_b128 v[128:131], v152 offset:1024
    s_waitcnt lgkmcnt(2)
    v_mfma_f32_32x32x16_bf16 v[108:123], v[136:139], v[92:95], v[108:123]
    v_exp_f32 v40, v40
    v_exp_f32 v41, v41
    v_exp_f32 v42, v42
    v_exp_f32 v43, v43
    v_cvt_pk_bf16_f32 v96, v36, v37
    v_cvt_pk_bf16_f32 v97, v38, v39
    s_add_u32 m0, s93, s71
    s_add_u32 s69, s69, 10240
    buffer_load_dwordx4 v196, s[12:15], s69 offen sc1 lds
    v_mfma_f32_32x32x4_2b_bf16 v[60:91], v[132:133], v[8:9], v[60:91]
    v_cvt_pk_bf16_f32 v98, v40, v41
    v_cvt_pk_bf16_f32 v99, v42, v43
    ds_read_b64 v[132:133], v153 offset:8192
    v_exp_f32 v44, v44
    v_exp_f32 v45, v45
    v_exp_f32 v46, v46
    v_exp_f32 v47, v47
    v_exp_f32 v48, v48
    v_exp_f32 v49, v49
    v_exp_f32 v50, v50
    v_exp_f32 v51, v51
    v_cvt_pk_bf16_f32 v100, v44, v45
    v_cvt_pk_bf16_f32 v101, v46, v47
    s_min_u32 m0, s79, 159744
    s_add_u32 s79, s79, 8192
    buffer_load_dwordx4 v196, s[8:11], m0 offen sc1 lds
    s_setprio 0
    v_mfma_f32_32x32x16_bf16 v[108:123], v[140:143], v[96:99], v[108:123]
    v_cvt_pk_bf16_f32 v102, v48, v49
    v_cvt_pk_bf16_f32 v103, v50, v51
    v_exp_f32 v52, v52
    v_exp_f32 v53, v53
    v_exp_f32 v54, v54
    v_exp_f32 v55, v55
    v_exp_f32 v56, v56
    buffer_load_dwordx4 v[160:163], v196, s[12:15], s95 offen sc1
    s_add_u32 s95, s95, 1024
    v_mfma_f32_32x32x16_bf16 v[108:123], v[144:147], v[100:103], v[108:123]
    v_exp_f32 v57, v57
    v_exp_f32 v58, v58
    v_exp_f32 v59, v59
    v_cvt_pk_bf16_f32 v104, v52, v53
    v_cvt_pk_bf16_f32 v105, v54, v55
    v_cvt_pk_bf16_f32 v106, v56, v57
    v_cvt_pk_bf16_f32 v107, v58, v59
    s_min_u32 m0, s79, 159744
    s_add_u32 s79, s79, 8192
    buffer_load_dwordx4 v196, s[8:11], m0 offen sc1 lds
    s_setprio 1
    s_waitcnt lgkmcnt(0)
    v_mfma_f32_32x32x16_bf16 v[28:43], v[124:127], v[4:7], v[12:27]
    v_exp_f32 v60, v60
    v_exp_f32 v61, v61
    v_exp_f32 v62, v62
    v_exp_f32 v63, v63
    v_mfma_f32_32x32x16_bf16 v[108:123], v[148:151], v[104:107], v[108:123]
    s_mov_b64 exec, s[74:75]
    ds_read_b128 v[136:139], v154 offset:19968
    ds_read_b128 v[140:143], v154 offset:20608
    ds_read_b128 v[144:147], v154 offset:21248
    ds_read_b128 v[148:151], v154 offset:21888
    s_mov_b64 exec, -1
    v_exp_f32 v64, v64
    v_exp_f32 v65, v65
    v_exp_f32 v66, v66
    v_exp_f32 v67, v67
    buffer_load_dwordx4 v[160:163], v196, s[12:15], s95 offen sc1
    s_add_u32 s95, s95, 1024
    v_mfma_f32_32x32x16_bf16 v[44:59], v[128:131], v[4:7], v[12:27]
    ds_read_b128 v[124:127], v152 offset:2048
    v_cvt_pk_bf16_f32 v92, v60, v61
    v_cvt_pk_bf16_f32 v93, v62, v63
    v_cvt_pk_bf16_f32 v94, v64, v65
    v_cvt_pk_bf16_f32 v95, v66, v67
    v_exp_f32 v68, v68
    v_exp_f32 v69, v69
    v_exp_f32 v70, v70
    v_exp_f32 v71, v71
    ds_read_b128 v[128:131], v152 offset:3072
    s_min_u32 m0, s79, 159744
    s_add_u32 s79, s79, 8192
    buffer_load_dwordx4 v196, s[8:11], m0 offen sc1 lds
    s_waitcnt lgkmcnt(2)
    v_mfma_f32_32x32x16_bf16 v[108:123], v[136:139], v[92:95], v[108:123]
    v_exp_f32 v72, v72
    v_exp_f32 v73, v73
    v_exp_f32 v74, v74
    v_exp_f32 v75, v75
    v_cvt_pk_bf16_f32 v96, v68, v69
    v_cvt_pk_bf16_f32 v97, v70, v71
    v_mfma_f32_32x32x4_2b_bf16 v[28:59], v[132:133], v[8:9], v[28:59]
    v_cvt_pk_bf16_f32 v98, v72, v73
    v_cvt_pk_bf16_f32 v99, v74, v75
    ds_read_b64 v[132:133], v153 offset:9216
    v_exp_f32 v76, v76
    v_exp_f32 v77, v77
    v_exp_f32 v78, v78
    v_exp_f32 v79, v79
    v_exp_f32 v80, v80
    v_exp_f32 v81, v81
    v_exp_f32 v82, v82
    v_exp_f32 v83, v83
    v_cvt_pk_bf16_f32 v100, v76, v77
    v_cvt_pk_bf16_f32 v101, v78, v79
    s_setprio 0
    v_mfma_f32_32x32x16_bf16 v[108:123], v[140:143], v[96:99], v[108:123]
    v_cvt_pk_bf16_f32 v102, v80, v81
    v_cvt_pk_bf16_f32 v103, v82, v83
    v_exp_f32 v84, v84
    v_exp_f32 v85, v85
    s_cmp_lg_u32 s66, 0
    s_cbranch_scc1 L_nf_22
    s_call_b64 s[76:77], L_as_fin
L_nf_22:
    v_exp_f32 v86, v86
    v_exp_f32 v87, v87
    v_exp_f32 v88, v88
    v_mfma_f32_32x32x16_bf16 v[108:123], v[144:147], v[100:103], v[108:123]
    v_exp_f32 v89, v89
    v_exp_f32 v90, v90
    v_exp_f32 v91, v91
    v_cvt_pk_bf16_f32 v104, v84, v85
    v_cvt_pk_bf16_f32 v105, v86, v87
    v_cvt_pk_bf16_f32 v106, v88, v89
    v_cvt_pk_bf16_f32 v107, v90, v91
    v_add_u32 v154, s72, v154
    s_add_u32 s66, s66, 1
    s_add_u32 s71, s71, s78
    s_mov_b32 s54, s72
    s_mov_b32 s72, s83
    s_mov_b32 s83, s78
    s_mov_b32 s78, s54
    s_cmp_lt_u32 s66, 8
    s_cbranch_scc1 L_att_young
    s_setprio 0
L_att_done:
    s_waitcnt lgkmcnt(3)
    v_mfma_f32_32x32x16_bf16 v[108:123], v[148:151], v[104:107], v[108:123]
    s_waitcnt lgkmcnt(0)
    s_mov_b32 s57, 0
    s_nop 9
L_att_norm:
    v_mov_b32 v1, v116
    v_mov_b32 v2, v116
    v_mov_b32 v3, 0x203
    v_mov_b32 v10, 0x53800000
    v_permlane32_swap_b32 v1, v2
    s_nop 0
    v_rcp_f32 v1, v2
    v_cmp_nle_f32 vcc, v2, v10
    v_mul_f32 v108, v1, v108
    v_mul_f32 v109, v1, v109
    v_mul_f32 v110, v1, v110
    v_mul_f32 v111, v1, v111
    v_mul_f32 v112, v1, v112
    v_mul_f32 v113, v1, v113
    v_mul_f32 v114, v1, v114
    v_mul_f32 v115, v1, v115
    v_cvt_pk_bf16_f32 v92, v108, v109
    v_cvt_pk_bf16_f32 v93, v110, v111
    v_cvt_pk_bf16_f32 v94, v112, v113
    v_cvt_pk_bf16_f32 v95, v114, v115
    buffer_store_dwordx4 v[92:95], v165, s[12:15], s80 offen sc1
    v_mul_f32 v116, v1, v116
    v_mul_f32 v117, v1, v117
    v_mul_f32 v118, v1, v118
    v_mul_f32 v119, v1, v119
    v_cvt_pk_bf16_f32 v96, v116, v117
    v_cvt_pk_bf16_f32 v97, v118, v119
    s_mov_b64 exec, 0xffffffff
    buffer_store_dwordx2 v[96:97], v166, s[12:15], s81 offen sc1
    s_mov_b64 exec, -1
    v_add_f32 v1, abs(v108), abs(v109)
    v_add_f32 v2, abs(v110), abs(v111)
    v_add_f32 v1, abs(v112), v1
    v_add_f32 v2, abs(v113), v2
    v_add_f32 v1, abs(v114), v1
    v_add_f32 v2, abs(v115), v2
    v_add_f32 v1, abs(v116), v1
    v_add_f32 v2, abs(v117), v2
    v_add_f32 v1, abs(v118), v1
    v_add_f32 v2, abs(v119), v2
    v_add_f32 v1, v1, v2
    v_cmp_class_f32 s[60:61], v1, v3
    s_cmp_lg_u32 s57, 0
    s_cbranch_scc1 L_att_end
    s_or_b64 vcc, vcc, s[60:61]
    s_cbranch_scc1 L_att_fb
    s_branch L_att_end
L_att_side:
    s_bitcmp1_b32 s66, 2
    s_cbranch_scc1 L_as_hi
    s_cmp_lt_u32 s66, 1
    s_cbranch_scc1 L_as_0
    s_cmp_lt_u32 s66, 2
    s_cbranch_scc1 L_as_1
    s_cmp_lt_u32 s66, 3
    s_cbranch_scc1 L_as_2
    s_mov_b32 s54, 30408704
    buffer_load_dwordx4 v[184:187], v196, s[12:15], s54 offen sc1
    buffer_load_dwordx4 v[188:191], v196, s[12:15], s54 offen offset:1024 sc1
    s_setpc_b64 s[76:77]
L_as_2:
    s_lshl_b32 s54, s2, 3
    s_add_u32 s54, s54, 30408704
    s_cmp_lg_u32 s28, 0
    s_cbranch_scc1 L_nofl_23
    v_mov_b32 v184, s32
    v_mov_b32 v185, s33
    v_mov_b32 v186, 0
    s_mov_b64 exec, 1
    buffer_store_dwordx2 v[184:185], v186, s[12:15], s54 offen sc1
    s_mov_b64 exec, -1
L_nofl_23:
    s_setpc_b64 s[76:77]
L_as_fin:
    s_waitcnt vmcnt(8)
    s_sub_u32 s54, s28, 1
    s_cmp_ge_u32 s54, 5
    s_cbranch_scc1 L_rlsk_24
    ds_read_b64_tr_b16 v[168:169], v158 offset:0
    ds_read_b64_tr_b16 v[170:171], v158 offset:2048
    ds_read_b64_tr_b16 v[172:173], v158 offset:32
    ds_read_b64_tr_b16 v[174:175], v158 offset:2080
    ds_read_b64_tr_b16 v[176:177], v158 offset:64
    ds_read_b64_tr_b16 v[178:179], v158 offset:2112
    ds_read_b64_tr_b16 v[180:181], v158 offset:96
    ds_read_b64_tr_b16 v[182:183], v158 offset:2144
    v_lshlrev_b32 v184, 4, v0
    s_waitcnt lgkmcnt(6)
    buffer_store_dwordx4 v[168:171], v184, s[12:15], s88 offen sc1
    s_waitcnt lgkmcnt(4)
    buffer_store_dwordx4 v[172:175], v184, s[12:15], s89 offen sc1
    s_waitcnt lgkmcnt(2)
    buffer_store_dwordx4 v[176:179], v184, s[12:15], s90 offen sc1
    s_waitcnt lgkmcnt(0)
    buffer_store_dwordx4 v[180:183], v184, s[12:15], s91 offen sc1
    s_cmp_eq_u32 s92, -1
    s_cbranch_scc1 L_rlsk_24
    v_mov_b32 v186, 0
    v_mov_b32 v187, 0
    v_mov_b32 v188, 0
    v_mov_b32 v189, 0
    v_mov_b32 v190, 0x3f803f80
    v_dot2_f32_bf16 v186, v168, v190, v186
    v_dot2_f32_bf16 v187, v172, v190, v187
    v_dot2_f32_bf16 v188, v176, v190, v188
    v_dot2_f32_bf16 v189, v180, v190, v189
    v_dot2_f32_bf16 v186, v169, v190, v186
    v_dot2_f32_bf16 v187, v173, v190, v187
    v_dot2_f32_bf16 v188, v177, v190, v188
    v_dot2_f32_bf16 v189, v181, v190, v189
    v_dot2_f32_bf16 v186, v170, v190, v186
    v_dot2_f32_bf16 v187, v174, v190, v187
    v_dot2_f32_bf16 v188, v178, v190, v188
    v_dot2_f32_bf16 v189, v182, v190, v189
    v_dot2_f32_bf16 v186, v171, v190, v186
    v_dot2_f32_bf16 v187, v175, v190, v187
    v_dot2_f32_bf16 v188, v179, v190, v188
    v_dot2_f32_bf16 v189, v183, v190, v189
    v_lshlrev_b32 v185, 2, v0
    s_nop 1
    v_permlane16_swap_b32 v186, v187
    v_permlane16_swap_b32 v188, v189
    s_nop 0
    v_add_f32 v186, v186, v187
    v_add_f32 v188, v188, v189
    s_nop 1
    v_permlane32_swap_b32 v186, v188
    s_nop 0
    v_add_f32 v186, v186, v188
    buffer_store_dword v186, v185, s[12:15], s92 offen sc1
L_rlsk_24:
    s_nop 1
L_as_0:
L_as_1:
    s_setpc_b64 s[76:77]
L_as_hi:
    s_cmp_eq_u32 s66, 7
    s_cbranch_scc1 L_as_7
    s_cmp_eq_u32 s66, 6
    s_cbranch_scc1 L_as_6
    s_cmp_eq_u32 s66, 5
    s_cbranch_scc1 L_as_5
    v_cmp_ne_u64 vcc, s[32:33], v[184:185]
    v_cmp_ne_u64 s[60:61], s[32:33], v[186:187]
    s_and_b32 s55, s30, 7
    s_or_b64 s[58:59], vcc, s[60:61]
    v_cmp_ne_u64 vcc, s[32:33], v[188:189]
    v_cmp_ne_u64 s[60:61], s[32:33], v[190:191]
    s_add_u32 s79, s73, 67584
    s_lshl_b32 s56, s30, 3
    s_add_u32 s56, s56, s28
    s_mul_i32 s95, s56, 8640
    s_add_u32 s95, s95, 26214400
    s_and_b32 s56, s30, 15
    s_mul_i32 s96, s56, 143360
    s_add_u32 s96, s96, s73
    s_add_u32 s96, s96, 23068672
    s_or_b64 s[58:59], s[58:59], vcc
    s_or_b64 s[58:59], s[58:59], s[60:61]
    s_cbranch_scc0 L_as_ret
    s_mov_b32 s57, 30408704
    s_mov_b32 s62, 0
    v_lshlrev_b32 v192, 4, v0
L_poll_26:
    buffer_load_dwordx4 v[184:187], v192, s[12:15], s57 offen sc1
    buffer_load_dwordx4 v[188:191], v192, s[12:15], s57 offen offset:1024 sc1
    s_add_u32 s62, s62, 1
    s_waitcnt vmcnt(0)
    v_cmp_ne_u64 vcc, s[32:33], v[184:185]
    v_cmp_ne_u64 s[60:61], s[32:33], v[186:187]
    s_nop 0
    s_or_b64 s[58:59], vcc, s[60:61]
    v_cmp_ne_u64 vcc, s[32:33], v[188:189]
    v_cmp_ne_u64 s[60:61], s[32:33], v[190:191]
    s_nop 0
    s_or_b64 s[58:59], s[58:59], vcc
    s_or_b64 s[58:59], s[58:59], s[60:61]
    s_cbranch_scc0 L_polld_27
    s_cmp_lt_u32 s62, 200000
    s_cbranch_scc1 L_poll_26
L_polld_27:
L_as_ret:
    s_add_u32 s54, s96, 0
    buffer_load_dwordx4 v[172:175], v196, s[12:15], s54 offen sc1
    s_add_u32 s54, s96, 8192
    buffer_load_dwordx4 v[176:179], v196, s[12:15], s54 offen sc1
    s_add_u32 s54, s96, 16384
    buffer_load_dwordx4 v[180:183], v196, s[12:15], s54 offen sc1
    s_add_u32 s54, s96, 24576
    buffer_load_dwordx4 v[184:187], v196, s[12:15], s54 offen sc1
    s_setpc_b64 s[76:77]
L_as_5:
    s_add_u32 s54, s96, 32768
    buffer_load_dwordx4 v[188:191], v196, s[12:15], s54 offen sc1
    s_add_u32 s54, s96, 40960
    buffer_load_dwordx4 v[192:195], v196, s[12:15], s54 offen sc1
    s_add_u32 s54, s96, 49152
    buffer_load_dwordx4 v[204:207], v196, s[12:15], s54 offen sc1
    s_add_u32 s54, s96, 57344
    buffer_load_dwordx4 v[208:211], v196, s[12:15], s54 offen sc1
    s_add_u32 s54, s96, 65536
    buffer_load_dwordx4 v[212:215], v196, s[12:15], s54 offen sc1
    s_setpc_b64 s[76:77]
L_as_6:
    s_mov_b32 s67, 0x7f000000
    s_mov_b32 s68, 0x7f000000
    s_mov_b32 s69, 0x7f000000
    s_add_u32 s54, s96, 73728
    buffer_load_dwordx4 v[216:219], v196, s[12:15], s54 offen sc1
    s_add_u32 s54, s96, 81920
    buffer_load_dwordx4 v[220:223], v196, s[12:15], s54 offen sc1
    s_add_u32 s54, s96, 90112
    buffer_load_dwordx4 v[224:227], v196, s[12:15], s54 offen sc1
    s_add_u32 s54, s96, 98304
    buffer_load_dwordx4 v[228:231], v196, s[12:15], s54 offen sc1
    s_add_u32 s54, s96, 106496
    buffer_load_dwordx4 v[232:235], v196, s[12:15], s54 offen sc1
    s_setpc_b64 s[76:77]
L_as_7:
    s_add_u32 s54, s96, 114688
    buffer_load_dwordx4 v[236:239], v196, s[12:15], s54 offen sc1
    s_add_u32 s54, s96, 122880
    buffer_load_dwordx4 v[240:243], v196, s[12:15], s54 offen sc1
    s_add_u32 s54, s96, 131072
    buffer_load_dwordx4 v[244:247], v196, s[12:15], s54 offen sc1
    s_add_u32 s54, s96, 139264
    s_cmp_ge_u32 s28, 4
    s_cselect_b32 s54, 0x7f000000, s54
    buffer_load_dwordx4 v[248:251], v196, s[12:15], s54 offen sc1
    s_setpc_b64 s[76:77]
L_late_17:
    s_mov_b32 s62, 0
L_lsp_28:
    ds_read_b32 v164, v159
    s_add_u32 s62, s62, 1
    s_cmp_ge_u32 s62, 3200000
    s_cbranch_scc1 L_go_18
    s_waitcnt lgkmcnt(0)
    v_cmp_lt_u32 vcc, v164, v156
    s_cbranch_vccnz L_lsp_28
    s_branch L_go_18
L_late_20:
    s_mov_b32 s62, 0
L_lsp_29:
    ds_read_b32 v164, v159
    s_add_u32 s62, s62, 1
    s_cmp_ge_u32 s62, 3200000
    s_cbranch_scc1 L_go_21
    s_waitcnt lgkmcnt(0)
    v_cmp_lt_u32 vcc, v164, v156
    s_cbranch_vccnz L_lsp_29
    s_branch L_go_21
L_att_fb:
    s_and_b32 s54, s64, 1
    s_lshl_b32 s54, s54, 3
    v_add_u32 v61, s54, v196
    v_lshrrev_b32 v62, 5, v0
    v_mul_u32_u24 v62, 20, v62
    v_and_b32 v63, 31, v0
    v_add_lshl_u32 v62, v62, v63, 4
    v_mov_b32 v60, 0xff800000
    s_lshl_b32 s55, s64, 16
    s_add_u32 s55, s55, 2621440
    s_lshr_b32 s56, s64, 1
    s_lshl_b32 s56, s56, 15
    s_add_u32 s56, s56, 4718592
    s_mul_i32 s57, s64, 81920
    s_add_u32 s57, s57, 5242880
    s_mov_b32 s54, 0
L_fb_max:
    buffer_load_dwordx4 v[124:127], v197, s[12:15], s55 offen sc1
    buffer_load_dwordx4 v[128:131], v197, s[12:15], s55 offen offset:512 sc1
    buffer_load_dwordx2 v[132:133], v61, s[12:15], s56 offen sc1
    s_waitcnt vmcnt(0)
    v_mfma_f32_32x32x16_bf16 v[28:43], v[124:127], v[4:7], 0
    v_mfma_f32_32x32x16_bf16 v[44:59], v[128:131], v[4:7], 0
    s_nop 9
    v_mfma_f32_32x32x4_2b_bf16 v[28:59], v[132:133], v[8:9], v[28:59]
    s_nop 15
    s_nop 3
    v_max3_f32 v60, v28, v29, v60
    v_max3_f32 v60, v30, v31, v60
    v_max3_f32 v60, v32, v33, v60
    v_max3_f32 v60, v34, v35, v60
    v_max3_f32 v60, v36, v37, v60
    v_max3_f32 v60, v38, v39, v60
    v_max3_f32 v60, v40, v41, v60
    v_max3_f32 v60, v42, v43, v60
    v_max3_f32 v60, v44, v45, v60
    v_max3_f32 v60, v46, v47, v60
    v_max3_f32 v60, v48, v49, v60
    v_max3_f32 v60, v50, v51, v60
    v_max3_f32 v60, v52, v53, v60
    v_max3_f32 v60, v54, v55, v60
    v_max3_f32 v60, v56, v57, v60
    v_max3_f32 v60, v58, v59, v60
    s_add_u32 s55, s55, 1024
    s_add_u32 s56, s56, 1024
    s_add_u32 s57, s57, 2560
    s_add_u32 s54, s54, 1
    s_cmp_lt_u32 s54, 32
    s_cbranch_scc1 L_fb_max
    v_mov_b32 v64, v60
    s_nop 1
    v_permlane32_swap_b32 v60, v64
    s_nop 0
    v_max_f32 v60, v60, v64
    v_sub_f32 v12, 0, v60
    v_sub_f32 v13, 0, v60
    v_sub_f32 v14, 0, v60
    v_sub_f32 v15, 0, v60
    v_sub_f32 v16, 0, v60
    v_sub_f32 v17, 0, v60
    v_sub_f32 v18, 0, v60
    v_sub_f32 v19, 0, v60
    v_sub_f32 v20, 0, v60
    v_sub_f32 v21, 0, v60
    v_sub_f32 v22, 0, v60
    v_sub_f32 v23, 0, v60
    v_sub_f32 v24, 0, v60
    v_sub_f32 v25, 0, v60
    v_sub_f32 v26, 0, v60
    v_sub_f32 v27, 0, v60
    v_mov_b32 v108, 0
    v_mov_b32 v109, 0
    v_mov_b32 v110, 0
    v_mov_b32 v111, 0
    v_mov_b32 v112, 0
    v_mov_b32 v113, 0
    v_mov_b32 v114, 0
    v_mov_b32 v115, 0
    v_mov_b32 v116, 0
    v_mov_b32 v117, 0
    v_mov_b32 v118, 0
    v_mov_b32 v119, 0
    v_mov_b32 v120, 0
    v_mov_b32 v121, 0
    v_mov_b32 v122, 0
    v_mov_b32 v123, 0
    s_lshl_b32 s55, s64, 16
    s_add_u32 s55, s55, 2621440
    s_lshr_b32 s56, s64, 1
    s_lshl_b32 s56, s56, 15
    s_add_u32 s56, s56, 4718592
    s_mul_i32 s57, s64, 81920
    s_add_u32 s57, s57, 5242880
    s_mov_b32 s54, 0
L_fb_acc:
    buffer_load_dwordx4 v[124:127], v197, s[12:15], s55 offen sc1
    buffer_load_dwordx4 v[128:131], v197, s[12:15], s55 offen offset:512 sc1
    buffer_load_dwordx2 v[132:133], v61, s[12:15], s56 offen sc1
    s_mov_b64 exec, s[74:75]
    buffer_load_dwordx4 v[136:139], v62, s[12:15], s57 offen offset:0 sc1
    buffer_load_dwordx4 v[140:143], v62, s[12:15], s57 offen offset:640 sc1
    buffer_load_dwordx4 v[144:147], v62, s[12:15], s57 offen offset:1280 sc1
    buffer_load_dwordx4 v[148:151], v62, s[12:15], s57 offen offset:1920 sc1
    s_mov_b64 exec, -1
    s_waitcnt vmcnt(0)
    v_mfma_f32_32x32x16_bf16 v[28:43], v[124:127], v[4:7], v[12:27]
    v_mfma_f32_32x32x16_bf16 v[44:59], v[128:131], v[4:7], v[12:27]
    s_nop 9
    v_mfma_f32_32x32x4_2b_bf16 v[28:59], v[132:133], v[8:9], v[28:59]
    s_nop 15
    s_nop 3
    v_exp_f32 v28, v28
    v_exp_f32 v29, v29
    v_exp_f32 v30, v30
    v_exp_f32 v31, v31
    v_exp_f32 v32, v32
    v_exp_f32 v33, v33
    v_exp_f32 v34, v34
    v_exp_f32 v35, v35
    v_exp_f32 v36, v36
    v_exp_f32 v37, v37
    v_exp_f32 v38, v38
    v_exp_f32 v39, v39
    v_exp_f32 v40, v40
    v_exp_f32 v41, v41
    v_exp_f32 v42, v42
    v_exp_f32 v43, v43
    v_exp_f32 v44, v44
    v_exp_f32 v45, v45
    v_exp_f32 v46, v46
    v_exp_f32 v47, v47
    v_exp_f32 v48, v48
    v_exp_f32 v49, v49
    v_exp_f32 v50, v50
    v_exp_f32 v51, v51
    v_exp_f32 v52, v52
    v_exp_f32 v53, v53
    v_exp_f32 v54, v54
    v_exp_f32 v55, v55
    v_exp_f32 v56, v56
    v_exp_f32 v57, v57
    v_exp_f32 v58, v58
    v_exp_f32 v59, v59
    s_nop 0
    v_cvt_pk_bf16_f32 v92, v28, v29
    v_cvt_pk_bf16_f32 v93, v30, v31
    v_cvt_pk_bf16_f32 v94, v32, v33
    v_cvt_pk_bf16_f32 v95, v34, v35
    v_cvt_pk_bf16_f32 v96, v36, v37
    v_cvt_pk_bf16_f32 v97, v38, v39
    v_cvt_pk_bf16_f32 v98, v40, v41
    v_cvt_pk_bf16_f32 v99, v42, v43
    v_cvt_pk_bf16_f32 v100, v44, v45
    v_cvt_pk_bf16_f32 v101, v46, v47
    v_cvt_pk_bf16_f32 v102, v48, v49
    v_cvt_pk_bf16_f32 v103, v50, v51
    v_cvt_pk_bf16_f32 v104, v52, v53
    v_cvt_pk_bf16_f32 v105, v54, v55
    v_cvt_pk_bf16_f32 v106, v56, v57
    v_cvt_pk_bf16_f32 v107, v58, v59
    s_nop 1
    v_mfma_f32_32x32x16_bf16 v[108:123], v[136:139], v[92:95], v[108:123]
    v_mfma_f32_32x32x16_bf16 v[108:123], v[140:143], v[96:99], v[108:123]
    v_mfma_f32_32x32x16_bf16 v[108:123], v[144:147], v[100:103], v[108:123]
    v_mfma_f32_32x32x16_bf16 v[108:123], v[148:151], v[104:107], v[108:123]
    s_add_u32 s55, s55, 1024
    s_add_u32 s56, s56, 1024
    s_add_u32 s57, s57, 2560
    s_add_u32 s54, s54, 1
    s_cmp_lt_u32 s54, 32
    s_cbranch_scc1 L_fb_acc
    s_mov_b32 s57, 1
    s_nop 11
    s_branch L_att_norm
L_att_end:
    s_lshl_b32 s54, s65, 5
    s_add_u32 s54, s54, s64
    s_mul_i32 s57, s54, 128
    s_add_u32 s57, s57, 30474240
    s_and_b32 s64, s28, 3
    s_lshr_b32 s65, s28, 2
    s_and_b32 s66, s30, 7
    s_lshl_b32 s67, s29, 2
    s_lshr_b32 s54, s30, 3
    s_add_u32 s67, s67, s54
    s_sub_u32 s72, s73, 1024
    s_add_u32 s68, s94, s72
    s_mul_i32 s83, s66, 276480
    s_add_u32 s83, s83, s73
    s_add_u32 s83, s83, 26214400
    v_lshlrev_b32 v197, 3, v0
    v_lshrrev_b32 v254, 5, v0
    v_and_b32 v80, 15, v0
    v_lshlrev_b32 v80, 4, v80
    v_lshl_add_u32 v254, v254, 8, v80
    v_add_u32 v1, s73, v196
    v_add_u32 v2, 0x10000, v1
    v_add_u32 v3, 0x20000, v1
    v_mov_b32 v84, s32
    v_mov_b32 v85, s33
    v_mov_b32 v86, 0
    s_waitcnt vmcnt(0)
    s_barrier
    s_cmp_lg_u32 s28, 0
    s_cbranch_scc1 L_nofl_30
    s_mov_b64 exec, 1
    buffer_store_dwordx2 v[84:85], v86, s[12:15], s57 offen sc1
    s_mov_b64 exec, -1
L_nofl_30:
    s_cmp_eq_u32 s28, 0
    s_cbranch_scc1 L_nw0_31
    s_add_u32 m0, s72, 57344
    s_add_u32 s54, s68, 92160
    buffer_load_dwordx4 v196, s[12:15], s54 offen sc1 lds
    s_add_u32 m0, s72, 64512
    s_add_u32 s54, s68, 99328
    s_cmp_ge_u32 s28, 4
    s_cselect_b32 m0, 162816, m0
    s_cselect_b32 s54, 0x7f000000, s54
    buffer_load_dwordx4 v196, s[12:15], s54 offen sc1 lds
L_nw0_31:
    s_lshr_b32 s54, s30, 3
    s_lshl_b32 s55, s29, 2
    s_add_u32 s54, s54, s55
    s_lshl_b32 s54, s54, 2
    s_and_b32 s55, s28, 3
    s_add_u32 s54, s54, s55
    s_mul_i32 s54, s54, 20480
    s_and_b32 s55, s30, 7
    s_mul_i32 s55, s55, 160
    s_add_u32 s54, s54, s55
    s_lshr_b32 s55, s28, 2
    s_lshl_b32 s55, s55, 6
    s_add_u32 s55, s55, s54
    v_lshrrev_b32 v80, 2, v0
    v_mul_u32_u24 v80, 1280, v80
    v_and_b32 v81, 3, v0
    v_lshl_add_u32 v80, v81, 3, v80
    buffer_load_dwordx2 v[198:199], v80, s[4:7], s55 offen
    buffer_load_dwordx2 v[200:201], v80, s[4:7], s55 offen offset:32
    buffer_load_dwordx2 v[202:203], v80, s[4:7], s54 offen offset:128
    ds_write_b128 v1, v[172:175] offset:0
    ds_write_b128 v1, v[176:179] offset:8192
    ds_write_b128 v1, v[180:183] offset:16384
    ds_write_b128 v1, v[184:187] offset:24576
    s_cmp_lt_u32 s28, 6
    s_cbranch_scc1 L_p3_nocs
    s_and_b32 s55, s30, 15
    s_sub_u32 s54, s28, 6
    s_lshl_b32 s54, s54, 6
    v_add_u32 v84, s54, v0
    s_mul_i32 s56, s55, 96
    v_add_u32 v85, s56, v84
    s_min_u32 s56, s55, 11
    s_lshl_b32 s56, s56, 4
    s_add_u32 s56, s56, 1536
    v_and_b32 v86, 15, v0
    v_add_u32 v86, s56, v86
    v_cmp_gt_u32 vcc, 96, v84
    s_mov_b32 s56, 29360128
    s_nop 0
    v_cndmask_b32 v85, v86, v85, vcc
    v_lshlrev_b32 v85, 2, v85
    buffer_load_dword v148, v85, s[12:15], s56 offen sc1
    s_add_u32 s56, s56, 6912
    buffer_load_dword v149, v85, s[12:15], s56 offen sc1
    s_add_u32 s56, s56, 6912
    buffer_load_dword v150, v85, s[12:15], s56 offen sc1
    s_add_u32 s56, s56, 6912
    buffer_load_dword v151, v85, s[12:15], s56 offen sc1
    s_add_u32 s56, s56, 6912
    buffer_load_dword v152, v85, s[12:15], s56 offen sc1
    s_add_u32 s56, s56, 6912
    buffer_load_dword v153, v85, s[12:15], s56 offen sc1
    s_add_u32 s56, s56, 6912
    buffer_load_dword v154, v85, s[12:15], s56 offen sc1
    s_add_u32 s56, s56, 6912
    buffer_load_dword v155, v85, s[12:15], s56 offen sc1
    s_add_u32 s56, s56, 6912
    buffer_load_dword v156, v85, s[12:15], s56 offen sc1
    s_add_u32 s56, s56, 6912
    buffer_load_dword v157, v85, s[12:15], s56 offen sc1
    s_add_u32 s56, s56, 6912
    buffer_load_dword v158, v85, s[12:15], s56 offen sc1
    s_add_u32 s56, s56, 6912
    buffer_load_dword v159, v85, s[12:15], s56 offen sc1
    s_add_u32 s56, s56, 6912
    buffer_load_dword v160, v85, s[12:15], s56 offen sc1
    s_add_u32 s56, s56, 6912
    buffer_load_dword v161, v85, s[12:15], s56 offen sc1
    s_add_u32 s56, s56, 6912
    buffer_load_dword v162, v85, s[12:15], s56 offen sc1
    s_add_u32 s56, s56, 6912
    buffer_load_dword v163, v85, s[12:15], s56 offen sc1
    s_add_u32 s56, s56, 6912
    buffer_load_dword v164, v85, s[12:15], s56 offen sc1
    s_add_u32 s56, s56, 6912
    buffer_load_dword v165, v85, s[12:15], s56 offen sc1
    s_add_u32 s56, s56, 6912
    buffer_load_dword v166, v85, s[12:15], s56 offen sc1
    s_add_u32 s56, s56, 6912
    buffer_load_dword v167, v85, s[12:15], s56 offen sc1
L_p3_nocs:
    s_mul_i32 s54, s65, 46080
    s_add_u32 s54, s54, 67584
    s_lshl_b32 s55, s65, 11
    v_add_u32 v74, s54, v196
    v_add_u32 v72, s55, v74
    v_subrev_u32 v73, s55, v74
    s_mul_i32 s54, s65, 5120
    s_add_u32 s54, s54, 57344
    s_lshl_b32 s55, s65, 11
    v_add_u32 v77, s54, v196
    v_add_u32 v75, s55, v77
    v_subrev_u32 v76, s55, v77
    s_mul_i32 s54, s64, 5120
    s_add_u32 s54, s54, 35840
    s_lshl_b32 s55, s65, 11
    s_add_u32 s56, s54, s55
    v_add_u32 v78, s56, v196
    s_sub_u32 s56, s54, s55
    s_add_u32 s56, s56, 2048
    v_add_u32 v79, s56, v196
    s_lshl_b32 s54, s67, 2
    s_add_u32 s81, s54, s64
    s_mul_i32 s68, s81, 20480
    s_mul_i32 s55, s65, 10240
    s_add_u32 s68, s68, s55
    s_add_u32 s68, s68, 8388608
    v_and_b32 v86, 15, v0
    v_lshrrev_b32 v87, 4, v0
    v_lshl_add_u32 v87, v86, 2, v87
    v_lshlrev_b32 v87, 2, v87
    s_mul_i32 s70, s81, 20480
    s_add_u32 s70, s70, 11534336
    s_lshl_b32 s54, s66, 1
    s_add_u32 s54, s54, s65
    s_lshl_b32 s71, s54, 10
    s_add_u32 s71, s71, s70
    s_lshl_b32 s55, s67, 4
    s_add_u32 s54, s54, s55
    s_lshl_b32 s54, s54, 9
    s_lshl_b32 s55, s64, 7
    s_add_u32 s54, s54, s55
    s_add_u32 s74, s54, 29884416
    s_lshr_b32 s54, s66, 1
    s_lshl_b32 s54, s54, 10
    s_and_b32 s55, s66, 1
    s_lshl_b32 s55, s55, 9
    s_add_u32 s54, s54, s55
    s_add_u32 s70, s70, s54
    s_add_u32 s70, s70, 16384
    s_lshl_b32 s54, s67, 3
    s_add_u32 s54, s54, s66
    s_mul_i32 s75, s54, 128
    s_add_u32 s75, s75, 30507008
    s_mul_i32 s57, s29, 4096
    s_add_u32 s57, s57, 30474240
    s_cmp_ge_u32 s28, 6
    s_cbranch_scc1 L_p3_w67
    s_waitcnt vmcnt(0)
L_p3_w67:
    s_waitcnt vmcnt(20)
    ds_bpermute_b32 v198, v87, v198
    ds_bpermute_b32 v199, v87, v199
    ds_bpermute_b32 v200, v87, v200
    ds_bpermute_b32 v201, v87, v201
    ds_bpermute_b32 v202, v87, v202
    ds_bpermute_b32 v203, v87, v203
    s_waitcnt lgkmcnt(0)
    s_sub_u32 s54, s65, 1
    v_lshlrev_b32 v44, 16, v198
    v_and_b32 v45, 0xffff0000, v198
    v_lshlrev_b32 v46, 16, v199
    v_and_b32 v47, 0xffff0000, v199
    v_lshlrev_b32 v48, 16, v200
    v_and_b32 v49, 0xffff0000, v200
    v_lshlrev_b32 v50, 16, v201
    v_and_b32 v51, 0xffff0000, v201
    v_and_b32 v82, s54, v202
    v_lshlrev_b32 v60, 16, v82
    v_and_b32 v61, 0xffff0000, v82
    v_and_b32 v82, s54, v203
    v_lshlrev_b32 v62, 16, v82
    v_and_b32 v63, 0xffff0000, v82
    v_mov_b32 v52, 0
    v_mov_b32 v53, 0
    v_mov_b32 v54, 0
    v_mov_b32 v55, 0
    v_mov_b32 v56, 0
    v_mov_b32 v57, 0
    v_mov_b32 v58, 0
    v_mov_b32 v59, 0
    s_cmp_lg_u32 s28, 0
    s_cbranch_scc1 L_polld_33
    s_mov_b32 s62, 0
    v_and_b32 v82, 31, v0
    v_mul_u32_u24 v82, 128, v82
L_poll_32:
    buffer_load_dwordx2 v[80:81], v82, s[12:15], s57 offen sc1
    s_add_u32 s62, s62, 1
    s_waitcnt vmcnt(0)
    v_cmp_ne_u64 vcc, s[32:33], v[80:81]
    s_nop 0
    s_or_b64 s[58:59], vcc, vcc
    s_cbranch_scc0 L_polld_33
    s_cmp_lt_u32 s62, 200000
    s_cbranch_scc1 L_poll_32
L_polld_33:
    s_barrier
    s_add_u32 s54, s68, 0
    buffer_load_dwordx4 v[4:7], v196, s[12:15], s54 offen sc1
    s_add_u32 s54, s68, 1024
    buffer_load_dwordx4 v[8:11], v196, s[12:15], s54 offen sc1
    s_add_u32 s54, s68, 2048
    buffer_load_dwordx4 v[12:15], v196, s[12:15], s54 offen sc1
    s_add_u32 s54, s68, 3072
    buffer_load_dwordx4 v[16:19], v196, s[12:15], s54 offen sc1
    ds_read_b128 v[88:91], v72 offset:0
    ds_read_b128 v[92:95], v72 offset:1024
    ds_read_b128 v[96:99], v73 offset:2048
    ds_read_b128 v[100:103], v73 offset:3072
    ds_read_b128 v[104:107], v74 offset:4096
    ds_read_b128 v[108:111], v72 offset:5120
    ds_read_b128 v[112:115], v72 offset:6144
    ds_read_b128 v[116:119], v73 offset:7168
    ds_read_b128 v[120:123], v73 offset:8192
    ds_read_b128 v[124:127], v74 offset:9216
    s_waitcnt vmcnt(3)
    s_waitcnt lgkmcnt(5)
    v_mfma_f32_16x16x32_bf16 v[44:47], v[88:91], v[4:7], v[44:47]
    ds_read_b128 v[128:131], v72 offset:10240
    v_mfma_f32_16x16x32_bf16 v[48:51], v[92:95], v[4:7], v[48:51]
    ds_read_b128 v[132:135], v72 offset:11264
    s_add_u32 s54, s68, 4096
    buffer_load_dwordx4 v[20:23], v196, s[12:15], s54 offen sc1
    v_mfma_f32_16x16x32_bf16 v[52:55], v[96:99], v[4:7], v[52:55]
    ds_read_b128 v[136:139], v73 offset:12288
    v_mfma_f32_16x16x32_bf16 v[56:59], v[100:103], v[4:7], v[56:59]
    ds_read_b128 v[140:143], v73 offset:13312
    v_mfma_f32_16x16x32_bf16 v[60:63], v[104:107], v[4:7], v[60:63]
    ds_read_b128 v[144:147], v74 offset:14336
    s_waitcnt vmcnt(3)
    s_waitcnt lgkmcnt(5)
    v_mfma_f32_16x16x32_bf16 v[44:47], v[108:111], v[8:11], v[44:47]
    ds_read_b128 v[88:91], v72 offset:15360
    v_mfma_f32_16x16x32_bf16 v[48:51], v[112:115], v[8:11], v[48:51]
    ds_read_b128 v[92:95], v72 offset:16384
    s_add_u32 s54, s68, 5120
    buffer_load_dwordx4 v[24:27], v196, s[12:15], s54 offen sc1
    v_mfma_f32_16x16x32_bf16 v[52:55], v[116:119], v[8:11], v[52:55]
    ds_read_b128 v[96:99], v73 offset:17408
    v_mfma_f32_16x16x32_bf16 v[56:59], v[120:123], v[8:11], v[56:59]
    ds_read_b128 v[100:103], v73 offset:18432
    v_mfma_f32_16x16x32_bf16 v[60:63], v[124:127], v[8:11], v[60:63]
    ds_read_b128 v[104:107], v74 offset:19456
    s_waitcnt vmcnt(3)
    s_waitcnt lgkmcnt(5)
    v_mfma_f32_16x16x32_bf16 v[44:47], v[128:131], v[12:15], v[44:47]
    ds_read_b128 v[108:111], v72 offset:20480
    v_mfma_f32_16x16x32_bf16 v[48:51], v[132:135], v[12:15], v[48:51]
    ds_read_b128 v[112:115], v72 offset:21504
    s_add_u32 s54, s68, 6144
    buffer_load_dwordx4 v[28:31], v196, s[12:15], s54 offen sc1
    v_mfma_f32_16x16x32_bf16 v[52:55], v[136:139], v[12:15], v[52:55]
    ds_read_b128 v[116:119], v73 offset:22528
    v_mfma_f32_16x16x32_bf16 v[56:59], v[140:143], v[12:15], v[56:59]
    ds_read_b128 v[120:123], v73 offset:23552
    v_mfma_f32_16x16x32_bf16 v[60:63], v[144:147], v[12:15], v[60:63]
    ds_read_b128 v[124:127], v74 offset:24576
    s_waitcnt vmcnt(3)
    s_waitcnt lgkmcnt(5)
    v_mfma_f32_16x16x32_bf16 v[44:47], v[88:91], v[16:19], v[44:47]
    ds_read_b128 v[128:131], v72 offset:25600
    v_mfma_f32_16x16x32_bf16 v[48:51], v[92:95], v[16:19], v[48:51]
    ds_read_b128 v[132:135], v72 offset:26624
    s_add_u32 s54, s68, 7168
    buffer_load_dwordx4 v[32:35], v196, s[12:15], s54 offen sc1
    v_mfma_f32_16x16x32_bf16 v[52:55], v[96:99], v[16:19], v[52:55]
    ds_read_b128 v[136:139], v73 offset:27648
    v_mfma_f32_16x16x32_bf16 v[56:59], v[100:103], v[16:19], v[56:59]
    ds_read_b128 v[140:143], v73 offset:28672
    v_mfma_f32_16x16x32_bf16 v[60:63], v[104:107], v[16:19], v[60:63]
    ds_read_b128 v[144:147], v74 offset:29696
    s_waitcnt vmcnt(3)
    s_waitcnt lgkmcnt(5)
    v_mfma_f32_16x16x32_bf16 v[44:47], v[108:111], v[20:23], v[44:47]
    ds_read_b128 v[88:91], v72 offset:30720
    v_mfma_f32_16x16x32_bf16 v[48:51], v[112:115], v[20:23], v[48:51]
    ds_read_b128 v[92:95], v72 offset:31744
    s_add_u32 s54, s68, 8192
    buffer_load_dwordx2 v[4:5], v197, s[12:15], s54 offen sc1
    buffer_load_dwordx2 v[6:7], v197, s[12:15], s54 offen offset:512 sc1
    v_mfma_f32_16x16x32_bf16 v[52:55], v[116:119], v[20:23], v[52:55]
    ds_read_b128 v[96:99], v73 offset:32768
    v_mfma_f32_16x16x32_bf16 v[56:59], v[120:123], v[20:23], v[56:59]
    ds_read_b128 v[100:103], v73 offset:33792
    v_mfma_f32_16x16x32_bf16 v[60:63], v[124:127], v[20:23], v[60:63]
    ds_read_b128 v[104:107], v74 offset:34816
    s_waitcnt vmcnt(4)
    s_waitcnt lgkmcnt(5)
    v_mfma_f32_16x16x32_bf16 v[44:47], v[128:131], v[24:27], v[44:47]
    ds_read_b128 v[108:111], v72 offset:35840
    v_mfma_f32_16x16x32_bf16 v[48:51], v[132:135], v[24:27], v[48:51]
    ds_read_b128 v[112:115], v72 offset:36864
    s_add_u32 s54, s68, 9216
    buffer_load_dwordx2 v[8:9], v197, s[12:15], s54 offen sc1
    buffer_load_dwordx2 v[10:11], v197, s[12:15], s54 offen offset:512 sc1
    v_mfma_f32_16x16x32_bf16 v[52:55], v[136:139], v[24:27], v[52:55]
    ds_read_b128 v[116:119], v73 offset:37888
    v_mfma_f32_16x16x32_bf16 v[56:59], v[140:143], v[24:27], v[56:59]
    ds_read_b128 v[120:123], v73 offset:38912
    v_mfma_f32_16x16x32_bf16 v[60:63], v[144:147], v[24:27], v[60:63]
    ds_read_b128 v[124:127], v74 offset:39936
    s_waitcnt vmcnt(5)
    s_waitcnt lgkmcnt(5)
    v_mfma_f32_16x16x32_bf16 v[44:47], v[88:91], v[28:31], v[44:47]
    ds_read_b128 v[128:131], v72 offset:40960
    v_mfma_f32_16x16x32_bf16 v[48:51], v[92:95], v[28:31], v[48:51]
    ds_read_b128 v[132:135], v72 offset:41984
    v_mfma_f32_16x16x32_bf16 v[52:55], v[96:99], v[28:31], v[52:55]
    ds_read_b128 v[136:139], v73 offset:43008
    v_mfma_f32_16x16x32_bf16 v[56:59], v[100:103], v[28:31], v[56:59]
    ds_read_b128 v[140:143], v73 offset:44032
    v_mfma_f32_16x16x32_bf16 v[60:63], v[104:107], v[28:31], v[60:63]
    ds_read_b128 v[144:147], v74 offset:45056
    s_waitcnt vmcnt(4)
    s_waitcnt lgkmcnt(5)
    v_mfma_f32_16x16x32_bf16 v[44:47], v[108:111], v[32:35], v[44:47]
    ds_read_b128 v[88:91], v75 offset:0
    v_mfma_f32_16x16x32_bf16 v[48:51], v[112:115], v[32:35], v[48:51]
    ds_read_b128 v[92:95], v75 offset:1024
    v_mfma_f32_16x16x32_bf16 v[52:55], v[116:119], v[32:35], v[52:55]
    ds_read_b128 v[96:99], v76 offset:2048
    v_mfma_f32_16x16x32_bf16 v[56:59], v[120:123], v[32:35], v[56:59]
    ds_read_b128 v[100:103], v76 offset:3072
    v_mfma_f32_16x16x32_bf16 v[60:63], v[124:127], v[32:35], v[60:63]
    ds_read_b128 v[104:107], v77 offset:4096
    s_waitcnt vmcnt(2)
    s_waitcnt lgkmcnt(5)
    v_mfma_f32_16x16x32_bf16 v[44:47], v[128:131], v[4:7], v[44:47]
    v_mfma_f32_16x16x32_bf16 v[48:51], v[132:135], v[4:7], v[48:51]
    v_mfma_f32_16x16x32_bf16 v[52:55], v[136:139], v[4:7], v[52:55]
    v_mfma_f32_16x16x32_bf16 v[56:59], v[140:143], v[4:7], v[56:59]
    v_mfma_f32_16x16x32_bf16 v[60:63], v[144:147], v[4:7], v[60:63]
    s_waitcnt vmcnt(0)
    s_waitcnt lgkmcnt(0)
    v_mfma_f32_16x16x32_bf16 v[44:47], v[88:91], v[8:11], v[44:47]
    v_mfma_f32_16x16x32_bf16 v[48:51], v[92:95], v[8:11], v[48:51]
    v_mfma_f32_16x16x32_bf16 v[52:55], v[96:99], v[8:11], v[52:55]
    v_mfma_f32_16x16x32_bf16 v[56:59], v[100:103], v[8:11], v[56:59]
    v_mfma_f32_16x16x32_bf16 v[60:63], v[104:107], v[8:11], v[60:63]
    s_nop 5
    ds_write_b128 v78, v[52:55]
    ds_write_b128 v78, v[56:59] offset:1024
    s_cmp_eq_u32 s65, 0
    s_cbranch_scc1 L_rh_34
    ds_write_b128 v78, v[60:63] offset:2048
L_rh_34:
    s_waitcnt lgkmcnt(0)
    s_barrier
    ds_read_b128 v[88:91], v79 offset:0
    ds_read_b128 v[92:95], v79 offset:1024
    ds_read_b128 v[96:99], v79 offset:2048
    s_waitcnt lgkmcnt(2)
    v_add_f32 v44, v44, v88
    v_add_f32 v45, v45, v89
    v_add_f32 v46, v46, v90
    v_add_f32 v47, v47, v91
    s_waitcnt lgkmcnt(1)
    v_add_f32 v48, v48, v92
    v_add_f32 v49, v49, v93
    v_add_f32 v50, v50, v94
    v_add_f32 v51, v51, v95
    s_waitcnt lgkmcnt(0)
    v_add_f32 v60, v60, v96
    v_add_f32 v61, v61, v97
    v_add_f32 v62, v62, v98
    v_add_f32 v63, v63, v99
    v_cvt_pk_bf16_f32 v198, v44, v45
    v_cvt_pk_bf16_f32 v199, v46, v47
    v_cvt_pk_bf16_f32 v200, v48, v49
    v_cvt_pk_bf16_f32 v201, v50, v51
    buffer_store_dwordx4 v[198:201], v196, s[12:15], s71 offen sc1
    v_cvt_pk_bf16_f32 v202, v60, v61
    v_cvt_pk_bf16_f32 v203, v62, v63
    v_mov_b32 v86, 0x3f803f80
    v_mov_b32 v82, 0
    v_mov_b32 v83, 0
    v_mov_b32 v84, 0
    v_mov_b32 v85, 0
    v_dot2_f32_bf16 v82, v198, v86, v82
    v_dot2_f32_bf16 v83, v198, v198, v83
    v_dot2_f32_bf16 v84, v199, v86, v84
    v_dot2_f32_bf16 v85, v199, v199, v85
    v_dot2_f32_bf16 v82, v200, v86, v82
    v_dot2_f32_bf16 v83, v200, v200, v83
    v_dot2_f32_bf16 v84, v201, v86, v84
    v_dot2_f32_bf16 v85, v201, v201, v85
    s_cmp_lg_u32 s65, 0
    s_cbranch_scc1 L_p3_no4
    v_dot2_f32_bf16 v82, v202, v86, v82
    v_dot2_f32_bf16 v83, v202, v202, v83
    v_dot2_f32_bf16 v84, v203, v86, v84
    v_dot2_f32_bf16 v85, v203, v203, v85
    v_mov_b32 v88, v202
    v_mov_b32 v89, v203
    v_mov_b32 v90, v202
    v_mov_b32 v91, v203
    s_nop 0
    v_permlane16_swap_b32 v88, v90
    v_permlane16_swap_b32 v89, v91
    s_mov_b32 exec_lo, 0xffff
    s_mov_b32 exec_hi, 0xffff
    buffer_store_dwordx4 v[88:91], v254, s[12:15], s70 offen sc1
    s_mov_b64 exec, -1
L_p3_no4:
    s_nop 0
    v_add_f32 v84, v84, v82
    v_add_f32 v85, v85, v83
    v_mov_b32 v86, v84
    v_mov_b32 v87, v85
    s_nop 0
    v_permlane16_swap_b32 v84, v86
    v_permlane16_swap_b32 v85, v87
    s_nop 0
    v_add_f32 v84, v84, v86
    v_add_f32 v85, v85, v87
    v_mov_b32 v86, v84
    v_mov_b32 v87, v85
    s_nop 0
    v_permlane32_swap_b32 v84, v86
    v_permlane32_swap_b32 v85, v87
    s_nop 0
    v_add_f32 v84, v84, v86
    v_add_f32 v85, v85, v87
    s_mov_b64 exec, 0xffff
    buffer_store_dwordx2 v[84:85], v197, s[12:15], s74 offen sc1
    s_mov_b64 exec, -1
    s_add_u32 s54, s83, 0
    buffer_load_dwordx4 v[172:175], v196, s[12:15], s54 offen sc1
    s_add_u32 s54, s83, 8192
    buffer_load_dwordx4 v[176:179], v196, s[12:15], s54 offen sc1
    s_add_u32 s54, s83, 16384
    buffer_load_dwordx4 v[180:183], v196, s[12:15], s54 offen sc1
    s_add_u32 s54, s83, 24576
    buffer_load_dwordx4 v[184:187], v196, s[12:15], s54 offen sc1
    ds_write_b128 v1, v[208:211] offset:57344
    ds_write_b128 v2, v[212:215] offset:0
    ds_write_b128 v2, v[216:219] offset:8192
    ds_write_b128 v2, v[220:223] offset:16384
    ds_write_b128 v2, v[224:227] offset:24576
    ds_write_b128 v2, v[228:231] offset:32768
    ds_write_b128 v2, v[232:235] offset:40960
    ds_write_b128 v2, v[236:239] offset:49152
    v_mov_b32 v80, s32
    v_mov_b32 v81, s33
    v_mov_b32 v82, 0
    s_waitcnt vmcnt(4)
    s_barrier
    s_cmp_lg_u32 s28, 0
    s_cbranch_scc1 L_nofl_35
    s_mov_b64 exec, 1
    buffer_store_dwordx2 v[80:81], v82, s[12:15], s75 offen sc1
    s_mov_b64 exec, -1
L_nofl_35:
    s_waitcnt lgkmcnt(0)
    s_add_u32 s54, s83, 57344
    buffer_load_dwordx4 v[208:211], v196, s[12:15], s54 offen sc1
    s_add_u32 s54, s83, 65536
    buffer_load_dwordx4 v[212:215], v196, s[12:15], s54 offen sc1
    s_add_u32 s54, s83, 138240
    buffer_load_dwordx4 v[216:219], v196, s[12:15], s54 offen sc1
    s_add_u32 s54, s83, 146432
    buffer_load_dwordx4 v[220:223], v196, s[12:15], s54 offen sc1
    ds_write_b128 v2, v[240:243] offset:57344
    ds_write_b128 v3, v[244:247] offset:0
    ds_write_b128 v3, v[248:251] offset:8192
    ds_write_b128 v1, v[188:191] offset:32768
    ds_write_b128 v1, v[192:195] offset:40960
    ds_write_b128 v1, v[204:207] offset:49152
    s_cmp_lt_u32 s28, 6
    s_cbranch_scc1 L_p4_nocs2
    v_add_f32 v148, v148, v158
    v_add_f32 v149, v149, v159
    v_add_f32 v150, v150, v160
    v_add_f32 v151, v151, v161
    v_add_f32 v152, v152, v162
    v_add_f32 v153, v153, v163
    v_add_f32 v154, v154, v164
    v_add_f32 v155, v155, v165
    v_add_f32 v156, v156, v166
    v_add_f32 v157, v157, v167
    v_add_f32 v148, v148, v153
    v_add_f32 v149, v149, v154
    v_add_f32 v150, v150, v155
    v_add_f32 v151, v151, v156
    v_add_f32 v152, v152, v157
    v_add_f32 v148, v148, v149
    v_add_f32 v148, v148, v150
    v_add_f32 v148, v148, v151
    v_add_f32 v148, v148, v152
    s_lshl_b32 s54, s28, 8
    s_add_u32 s54, s54, 160256
    v_lshl_add_u32 v84, v0, 2, s54
    ds_write_b32 v84, v148
L_p4_nocs2:
    s_and_b32 s70, s30, 15
    s_lshl_b32 s71, s29, 1
    s_lshr_b32 s54, s30, 4
    s_add_u32 s71, s71, s54
    v_mov_b32 v72, v196
    v_add_u32 v73, 64512, v196
    v_add_u32 v74, 129024, v196
    s_lshl_b32 s54, s71, 3
    s_add_u32 s74, s54, s28
    s_mul_i32 s68, s74, 20480
    s_add_u32 s68, s68, 11534336
    s_lshr_b32 s54, s74, 2
    s_lshl_b32 s54, s54, 13
    s_and_b32 s55, s74, 3
    s_lshl_b32 s55, s55, 7
    s_add_u32 s54, s54, s55
    s_add_u32 s69, s54, 29884416
    v_and_b32 v80, 15, v0
    v_lshrrev_b32 v81, 4, v0
    v_lshlrev_b32 v75, 11, v81
    v_lshl_add_u32 v75, v80, 3, v75
    v_lshlrev_b32 v76, 4, v81
    v_add_u32 v76, 161792, v76
    s_mul_i32 s57, s71, 2048
    s_add_u32 s57, s57, 30507008
    s_cmp_lg_u32 s28, 0
    s_cbranch_scc1 L_polld_37
    s_mov_b32 s62, 0
    v_and_b32 v82, 15, v0
    v_mul_u32_u24 v82, 128, v82
L_poll_36:
    buffer_load_dwordx2 v[80:81], v82, s[12:15], s57 offen sc1
    s_add_u32 s62, s62, 1
    s_waitcnt vmcnt(0)
    v_cmp_ne_u64 vcc, s[32:33], v[80:81]
    s_nop 0
    s_or_b64 s[58:59], vcc, vcc
    s_cbranch_scc0 L_polld_37
    s_cmp_lt_u32 s62, 200000
    s_cbranch_scc1 L_poll_36
L_polld_37:
    s_waitcnt lgkmcnt(0)
    s_barrier
    s_add_u32 s54, s68, 0
    buffer_load_dwordx4 v[4:7], v196, s[12:15], s54 offen sc1
    s_add_u32 s54, s68, 1024
    buffer_load_dwordx4 v[8:11], v196, s[12:15], s54 offen sc1
    s_add_u32 s54, s68, 2048
    buffer_load_dwordx4 v[12:15], v196, s[12:15], s54 offen sc1
    s_add_u32 s54, s68, 3072
    buffer_load_dwordx4 v[16:19], v196, s[12:15], s54 offen sc1
    ds_read_b128 v[88:91], v72 offset:0
    ds_read_b128 v[92:95], v72 offset:1024
    ds_read_b128 v[96:99], v72 offset:2048
    ds_read_b128 v[100:103], v72 offset:3072
    ds_read_b128 v[104:107], v72 offset:4096
    ds_read_b128 v[108:111], v72 offset:5120
    ds_read_b128 v[112:115], v72 offset:6144
    ds_read_b128 v[116:119], v72 offset:7168
    ds_read_b128 v[120:123], v72 offset:8192
    ds_read_b128 v[124:127], v72 offset:9216
    ds_read_b128 v[128:131], v72 offset:10240
    ds_read_b128 v[132:135], v72 offset:11264
    ds_read_b128 v[136:139], v72 offset:12288
    ds_read_b128 v[140:143], v72 offset:13312
    s_waitcnt vmcnt(3)
    s_waitcnt lgkmcnt(7)
    v_mfma_f32_16x16x32_bf16 v[44:47], v[88:91], v[4:7], 0
    ds_read_b128 v[144:147], v72 offset:14336
    v_mfma_f32_16x16x32_bf16 v[48:51], v[92:95], v[4:7], 0
    ds_read_b128 v[148:151], v72 offset:15360
    s_add_u32 s54, s68, 4096
    buffer_load_dwordx4 v[20:23], v196, s[12:15], s54 offen sc1
    v_mfma_f32_16x16x32_bf16 v[52:55], v[96:99], v[4:7], 0
    ds_read_b128 v[152:155], v72 offset:16384
    v_mfma_f32_16x16x32_bf16 v[56:59], v[100:103], v[4:7], 0
    ds_read_b128 v[156:159], v72 offset:17408
    v_mfma_f32_16x16x32_bf16 v[60:63], v[104:107], v[4:7], 0
    ds_read_b128 v[160:163], v72 offset:18432
    v_mfma_f32_16x16x32_bf16 v[64:67], v[108:111], v[4:7], 0
    ds_read_b128 v[164:167], v72 offset:19456
    v_mfma_f32_16x16x32_bf16 v[68:71], v[112:115], v[4:7], 0
    ds_read_b128 v[168:171], v72 offset:20480
    s_waitcnt vmcnt(3)
    s_waitcnt lgkmcnt(7)
    v_mfma_f32_16x16x32_bf16 v[44:47], v[116:119], v[8:11], v[44:47]
    ds_read_b128 v[88:91], v72 offset:21504
    v_mfma_f32_16x16x32_bf16 v[48:51], v[120:123], v[8:11], v[48:51]
    ds_read_b128 v[92:95], v72 offset:22528
    s_add_u32 s54, s68, 5120
    buffer_load_dwordx4 v[24:27], v196, s[12:15], s54 offen sc1
    v_mfma_f32_16x16x32_bf16 v[52:55], v[124:127], v[8:11], v[52:55]
    ds_read_b128 v[96:99], v72 offset:23552
    v_mfma_f32_16x16x32_bf16 v[56:59], v[128:131], v[8:11], v[56:59]
    ds_read_b128 v[100:103], v72 offset:24576
    v_mfma_f32_16x16x32_bf16 v[60:63], v[132:135], v[8:11], v[60:63]
    ds_read_b128 v[104:107], v72 offset:25600
    s_add_u32 s54, s83, 154624
    buffer_load_dwordx4 v[224:227], v196, s[12:15], s54 offen sc1
    v_mfma_f32_16x16x32_bf16 v[64:67], v[136:139], v[8:11], v[64:67]
    ds_read_b128 v[108:111], v72 offset:26624
    v_mfma_f32_16x16x32_bf16 v[68:71], v[140:143], v[8:11], v[68:71]
    ds_read_b128 v[112:115], v72 offset:27648
    s_waitcnt vmcnt(4)
    s_waitcnt lgkmcnt(7)
    v_mfma_f32_16x16x32_bf16 v[44:47], v[144:147], v[12:15], v[44:47]
    ds_read_b128 v[116:119], v72 offset:28672
    v_mfma_f32_16x16x32_bf16 v[48:51], v[148:151], v[12:15], v[48:51]
    ds_read_b128 v[120:123], v72 offset:29696
    s_add_u32 s54, s68, 6144
    buffer_load_dwordx4 v[28:31], v196, s[12:15], s54 offen sc1
    v_mfma_f32_16x16x32_bf16 v[52:55], v[152:155], v[12:15], v[52:55]
    ds_read_b128 v[124:127], v72 offset:30720
    v_mfma_f32_16x16x32_bf16 v[56:59], v[156:159], v[12:15], v[56:59]
    ds_read_b128 v[128:131], v72 offset:31744
    v_mfma_f32_16x16x32_bf16 v[60:63], v[160:163], v[12:15], v[60:63]
    ds_read_b128 v[132:135], v72 offset:32768
    v_mfma_f32_16x16x32_bf16 v[64:67], v[164:167], v[12:15], v[64:67]
    ds_read_b128 v[136:139], v72 offset:33792
    v_mfma_f32_16x16x32_bf16 v[68:71], v[168:171], v[12:15], v[68:71]
    ds_read_b128 v[140:143], v72 offset:34816
    s_waitcnt vmcnt(4)
    s_waitcnt lgkmcnt(7)
    v_mfma_f32_16x16x32_bf16 v[44:47], v[88:91], v[16:19], v[44:47]
    ds_read_b128 v[144:147], v72 offset:35840
    v_mfma_f32_16x16x32_bf16 v[48:51], v[92:95], v[16:19], v[48:51]
    ds_read_b128 v[148:151], v72 offset:36864
    s_add_u32 s54, s68, 7168
    buffer_load_dwordx4 v[32:35], v196, s[12:15], s54 offen sc1
    v_mfma_f32_16x16x32_bf16 v[52:55], v[96:99], v[16:19], v[52:55]
    ds_read_b128 v[152:155], v72 offset:37888
    v_mfma_f32_16x16x32_bf16 v[56:59], v[100:103], v[16:19], v[56:59]
    ds_read_b128 v[156:159], v72 offset:38912
    v_mfma_f32_16x16x32_bf16 v[60:63], v[104:107], v[16:19], v[60:63]
    ds_read_b128 v[160:163], v72 offset:39936
    s_add_u32 s54, s83, 162816
    buffer_load_dwordx4 v[228:231], v196, s[12:15], s54 offen sc1
    v_mfma_f32_16x16x32_bf16 v[64:67], v[108:111], v[16:19], v[64:67]
    ds_read_b128 v[164:167], v72 offset:40960
    v_mfma_f32_16x16x32_bf16 v[68:71], v[112:115], v[16:19], v[68:71]
    ds_read_b128 v[168:171], v72 offset:41984
    s_waitcnt vmcnt(5)
    s_waitcnt lgkmcnt(7)
    v_mfma_f32_16x16x32_bf16 v[44:47], v[116:119], v[20:23], v[44:47]
    ds_read_b128 v[88:91], v72 offset:43008
    v_mfma_f32_16x16x32_bf16 v[48:51], v[120:123], v[20:23], v[48:51]
    ds_read_b128 v[92:95], v72 offset:44032
    s_add_u32 s54, s68, 8192
    buffer_load_dwordx4 v[4:7], v196, s[12:15], s54 offen sc1
    v_mfma_f32_16x16x32_bf16 v[52:55], v[124:127], v[20:23], v[52:55]
    ds_read_b128 v[96:99], v72 offset:45056
    v_mfma_f32_16x16x32_bf16 v[56:59], v[128:131], v[20:23], v[56:59]
    ds_read_b128 v[100:103], v72 offset:46080
    v_mfma_f32_16x16x32_bf16 v[60:63], v[132:135], v[20:23], v[60:63]
    ds_read_b128 v[104:107], v72 offset:47104
    v_mfma_f32_16x16x32_bf16 v[64:67], v[136:139], v[20:23], v[64:67]
    ds_read_b128 v[108:111], v72 offset:48128
    v_mfma_f32_16x16x32_bf16 v[68:71], v[140:143], v[20:23], v[68:71]
    ds_read_b128 v[112:115], v72 offset:49152
    s_waitcnt vmcnt(5)
    s_waitcnt lgkmcnt(7)
    v_mfma_f32_16x16x32_bf16 v[44:47], v[144:147], v[24:27], v[44:47]
    ds_read_b128 v[116:119], v72 offset:50176
    v_mfma_f32_16x16x32_bf16 v[48:51], v[148:151], v[24:27], v[48:51]
    ds_read_b128 v[120:123], v72 offset:51200
    s_add_u32 s54, s68, 9216
    buffer_load_dwordx4 v[8:11], v196, s[12:15], s54 offen sc1
    v_mfma_f32_16x16x32_bf16 v[52:55], v[152:155], v[24:27], v[52:55]
    ds_read_b128 v[124:127], v72 offset:52224
    v_mfma_f32_16x16x32_bf16 v[56:59], v[156:159], v[24:27], v[56:59]
    ds_read_b128 v[128:131], v72 offset:53248
    v_mfma_f32_16x16x32_bf16 v[60:63], v[160:163], v[24:27], v[60:63]
    ds_read_b128 v[132:135], v72 offset:54272
    v_mfma_f32_16x16x32_bf16 v[64:67], v[164:167], v[24:27], v[64:67]
    ds_read_b128 v[136:139], v72 offset:55296
    v_mfma_f32_16x16x32_bf16 v[68:71], v[168:171], v[24:27], v[68:71]
    ds_read_b128 v[140:143], v72 offset:56320
    s_waitcnt vmcnt(4)
    s_waitcnt lgkmcnt(7)
    v_mfma_f32_16x16x32_bf16 v[44:47], v[88:91], v[28:31], v[44:47]
    ds_read_b128 v[144:147], v72 offset:57344
    v_mfma_f32_16x16x32_bf16 v[48:51], v[92:95], v[28:31], v[48:51]
    ds_read_b128 v[148:151], v72 offset:58368
    buffer_load_dwordx2 v[36:37], v75, s[12:15], s69 offen offset:0 sc1
    v_mfma_f32_16x16x32_bf16 v[52:55], v[96:99], v[28:31], v[52:55]
    ds_read_b128 v[152:155], v72 offset:59392
    v_mfma_f32_16x16x32_bf16 v[56:59], v[100:103], v[28:31], v[56:59]
    ds_read_b128 v[156:159], v72 offset:60416
    s_add_u32 s54, s68, 10240
    buffer_load_dwordx4 v[12:15], v196, s[12:15], s54 offen sc1
    v_mfma_f32_16x16x32_bf16 v[60:63], v[104:107], v[28:31], v[60:63]
    ds_read_b128 v[160:163], v72 offset:61440
    v_mfma_f32_16x16x32_bf16 v[64:67], v[108:111], v[28:31], v[64:67]
    ds_read_b128 v[164:167], v72 offset:62464
    s_add_u32 s54, s83, 171008
    buffer_load_dwordx4 v[232:235], v196, s[12:15], s54 offen sc1
    v_mfma_f32_16x16x32_bf16 v[68:71], v[112:115], v[28:31], v[68:71]
    ds_read_b128 v[168:171], v72 offset:63488
    s_waitcnt vmcnt(6)
    s_waitcnt lgkmcnt(7)
    v_mfma_f32_16x16x32_bf16 v[44:47], v[116:119], v[32:35], v[44:47]
    ds_read_b128 v[88:91], v73 offset:0
    v_mfma_f32_16x16x32_bf16 v[48:51], v[120:123], v[32:35], v[48:51]
    ds_read_b128 v[92:95], v73 offset:1024
    buffer_load_dwordx2 v[38:39], v75, s[12:15], s69 offen offset:512 sc1
    v_mfma_f32_16x16x32_bf16 v[52:55], v[124:127], v[32:35], v[52:55]
    ds_read_b128 v[96:99], v73 offset:2048
    v_mfma_f32_16x16x32_bf16 v[56:59], v[128:131], v[32:35], v[56:59]
    ds_read_b128 v[100:103], v73 offset:3072
    v_mfma_f32_16x16x32_bf16 v[60:63], v[132:135], v[32:35], v[60:63]
    ds_read_b128 v[104:107], v73 offset:4096
    s_add_u32 s54, s68, 11264
    buffer_load_dwordx4 v[16:19], v196, s[12:15], s54 offen sc1
    v_mfma_f32_16x16x32_bf16 v[64:67], v[136:139], v[32:35], v[64:67]
    ds_read_b128 v[108:111], v73 offset:5120
    v_mfma_f32_16x16x32_bf16 v[68:71], v[140:143], v[32:35], v[68:71]
    ds_read_b128 v[112:115], v73 offset:6144
    s_waitcnt vmcnt(6)
    s_waitcnt lgkmcnt(7)
    v_mfma_f32_16x16x32_bf16 v[44:47], v[144:147], v[4:7], v[44:47]
    ds_read_b128 v[116:119], v73 offset:7168
    v_mfma_f32_16x16x32_bf16 v[48:51], v[148:151], v[4:7], v[48:51]
    ds_read_b128 v[120:123], v73 offset:8192
    buffer_load_dwordx2 v[40:41], v75, s[12:15], s69 offen offset:1024 sc1
    v_mfma_f32_16x16x32_bf16 v[52:55], v[152:155], v[4:7], v[52:55]
    ds_read_b128 v[124:127], v73 offset:9216
    v_mfma_f32_16x16x32_bf16 v[56:59], v[156:159], v[4:7], v[56:59]
    ds_read_b128 v[128:131], v73 offset:10240
    v_mfma_f32_16x16x32_bf16 v[60:63], v[160:163], v[4:7], v[60:63]
    ds_read_b128 v[132:135], v73 offset:11264
    s_add_u32 s54, s68, 12288
    buffer_load_dwordx4 v[20:23], v196, s[12:15], s54 offen sc1
    v_mfma_f32_16x16x32_bf16 v[64:67], v[164:167], v[4:7], v[64:67]
    ds_read_b128 v[136:139], v73 offset:12288
    v_mfma_f32_16x16x32_bf16 v[68:71], v[168:171], v[4:7], v[68:71]
    ds_read_b128 v[140:143], v73 offset:13312
    s_waitcnt vmcnt(7)
    s_waitcnt lgkmcnt(7)
    v_mfma_f32_16x16x32_bf16 v[44:47], v[88:91], v[8:11], v[44:47]
    ds_read_b128 v[144:147], v73 offset:14336
    v_mfma_f32_16x16x32_bf16 v[48:51], v[92:95], v[8:11], v[48:51]
    ds_read_b128 v[148:151], v73 offset:15360
    buffer_load_dwordx2 v[42:43], v75, s[12:15], s69 offen offset:1536 sc1
    v_mfma_f32_16x16x32_bf16 v[52:55], v[96:99], v[8:11], v[52:55]
    ds_read_b128 v[152:155], v73 offset:16384
    v_mfma_f32_16x16x32_bf16 v[56:59], v[100:103], v[8:11], v[56:59]
    ds_read_b128 v[156:159], v73 offset:17408
    s_add_u32 s54, s68, 13312
    buffer_load_dwordx4 v[24:27], v196, s[12:15], s54 offen sc1
    v_mfma_f32_16x16x32_bf16 v[60:63], v[104:107], v[8:11], v[60:63]
    ds_read_b128 v[160:163], v73 offset:18432
    v_mfma_f32_16x16x32_bf16 v[64:67], v[108:111], v[8:11], v[64:67]
    ds_read_b128 v[164:167], v73 offset:19456
    s_add_u32 s54, s83, 179200
    buffer_load_dwordx4 v[236:239], v196, s[12:15], s54 offen sc1
    v_mfma_f32_16x16x32_bf16 v[68:71], v[112:115], v[8:11], v[68:71]
    ds_read_b128 v[168:171], v73 offset:20480
    s_waitcnt vmcnt(8)
    s_waitcnt lgkmcnt(7)
    v_mfma_f32_16x16x32_bf16 v[44:47], v[116:119], v[12:15], v[44:47]
    ds_read_b128 v[88:91], v73 offset:21504
    v_mfma_f32_16x16x32_bf16 v[48:51], v[120:123], v[12:15], v[48:51]
    ds_read_b128 v[92:95], v73 offset:22528
    s_add_u32 s54, s68, 14336
    buffer_load_dwordx4 v[28:31], v196, s[12:15], s54 offen sc1
    v_mfma_f32_16x16x32_bf16 v[52:55], v[124:127], v[12:15], v[52:55]
    ds_read_b128 v[96:99], v73 offset:23552
    v_mfma_f32_16x16x32_bf16 v[56:59], v[128:131], v[12:15], v[56:59]
    ds_read_b128 v[100:103], v73 offset:24576
    v_mfma_f32_16x16x32_bf16 v[60:63], v[132:135], v[12:15], v[60:63]
    ds_read_b128 v[104:107], v73 offset:25600
    v_mfma_f32_16x16x32_bf16 v[64:67], v[136:139], v[12:15], v[64:67]
    ds_read_b128 v[108:111], v73 offset:26624
    v_mfma_f32_16x16x32_bf16 v[68:71], v[140:143], v[12:15], v[68:71]
    ds_read_b128 v[112:115], v73 offset:27648
    s_waitcnt vmcnt(6)
    s_waitcnt lgkmcnt(7)
    v_mfma_f32_16x16x32_bf16 v[44:47], v[144:147], v[16:19], v[44:47]
    ds_read_b128 v[116:119], v73 offset:28672
    v_mfma_f32_16x16x32_bf16 v[48:51], v[148:151], v[16:19], v[48:51]
    ds_read_b128 v[120:123], v73 offset:29696
    s_add_u32 s54, s68, 15360
    buffer_load_dwordx4 v[32:35], v196, s[12:15], s54 offen sc1
    v_mfma_f32_16x16x32_bf16 v[52:55], v[152:155], v[16:19], v[52:55]
    ds_read_b128 v[124:127], v73 offset:30720
    v_mfma_f32_16x16x32_bf16 v[56:59], v[156:159], v[16:19], v[56:59]
    ds_read_b128 v[128:131], v73 offset:31744
    v_mfma_f32_16x16x32_bf16 v[60:63], v[160:163], v[16:19], v[60:63]
    ds_read_b128 v[132:135], v73 offset:32768
    s_add_u32 s54, s83, 187392
    buffer_load_dwordx4 v[240:243], v196, s[12:15], s54 offen sc1
    v_mfma_f32_16x16x32_bf16 v[64:67], v[164:167], v[16:19], v[64:67]
    ds_read_b128 v[136:139], v73 offset:33792
    v_mfma_f32_16x16x32_bf16 v[68:71], v[168:171], v[16:19], v[68:71]
    ds_read_b128 v[140:143], v73 offset:34816
    s_waitcnt vmcnt(6)
    s_waitcnt lgkmcnt(7)
    v_mfma_f32_16x16x32_bf16 v[44:47], v[88:91], v[20:23], v[44:47]
    ds_read_b128 v[144:147], v73 offset:35840
    v_mfma_f32_16x16x32_bf16 v[48:51], v[92:95], v[20:23], v[48:51]
    ds_read_b128 v[148:151], v73 offset:36864
    s_add_u32 s54, s68, 16384
    buffer_load_dwordx4 v[4:7], v196, s[12:15], s54 offen sc1
    v_mfma_f32_16x16x32_bf16 v[52:55], v[96:99], v[20:23], v[52:55]
    ds_read_b128 v[152:155], v73 offset:37888
    v_mfma_f32_16x16x32_bf16 v[56:59], v[100:103], v[20:23], v[56:59]
    ds_read_b128 v[156:159], v73 offset:38912
    v_mfma_f32_16x16x32_bf16 v[60:63], v[104:107], v[20:23], v[60:63]
    ds_read_b128 v[160:163], v73 offset:39936
    v_mfma_f32_16x16x32_bf16 v[64:67], v[108:111], v[20:23], v[64:67]
    ds_read_b128 v[164:167], v73 offset:40960
    v_mfma_f32_16x16x32_bf16 v[68:71], v[112:115], v[20:23], v[68:71]
    ds_read_b128 v[168:171], v73 offset:41984
    s_waitcnt vmcnt(5)
    s_waitcnt lgkmcnt(7)
    v_mfma_f32_16x16x32_bf16 v[44:47], v[116:119], v[24:27], v[44:47]
    ds_read_b128 v[88:91], v73 offset:43008
    v_mfma_f32_16x16x32_bf16 v[48:51], v[120:123], v[24:27], v[48:51]
    ds_read_b128 v[92:95], v73 offset:44032
    s_add_u32 s54, s68, 17408
    buffer_load_dwordx4 v[8:11], v196, s[12:15], s54 offen sc1
    v_mfma_f32_16x16x32_bf16 v[52:55], v[124:127], v[24:27], v[52:55]
    ds_read_b128 v[96:99], v73 offset:45056
    v_mfma_f32_16x16x32_bf16 v[56:59], v[128:131], v[24:27], v[56:59]
    ds_read_b128 v[100:103], v73 offset:46080
    v_mfma_f32_16x16x32_bf16 v[60:63], v[132:135], v[24:27], v[60:63]
    ds_read_b128 v[104:107], v73 offset:47104
    v_mfma_f32_16x16x32_bf16 v[64:67], v[136:139], v[24:27], v[64:67]
    ds_read_b128 v[108:111], v73 offset:48128
    v_mfma_f32_16x16x32_bf16 v[68:71], v[140:143], v[24:27], v[68:71]
    ds_read_b128 v[112:115], v73 offset:49152
    s_waitcnt vmcnt(4)
    s_waitcnt lgkmcnt(7)
    v_mfma_f32_16x16x32_bf16 v[44:47], v[144:147], v[28:31], v[44:47]
    ds_read_b128 v[116:119], v73 offset:50176
    v_mfma_f32_16x16x32_bf16 v[48:51], v[148:151], v[28:31], v[48:51]
    ds_read_b128 v[120:123], v73 offset:51200
    s_add_u32 s54, s68, 18432
    buffer_load_dwordx4 v[12:15], v196, s[12:15], s54 offen sc1
    v_mfma_f32_16x16x32_bf16 v[52:55], v[152:155], v[28:31], v[52:55]
    ds_read_b128 v[124:127], v73 offset:52224
    v_mfma_f32_16x16x32_bf16 v[56:59], v[156:159], v[28:31], v[56:59]
    ds_read_b128 v[128:131], v73 offset:53248
    s_add_u32 s54, s83, 195584
    buffer_load_dwordx4 v[244:247], v196, s[12:15], s54 offen sc1
    v_mfma_f32_16x16x32_bf16 v[60:63], v[160:163], v[28:31], v[60:63]
    ds_read_b128 v[132:135], v73 offset:54272
    v_mfma_f32_16x16x32_bf16 v[64:67], v[164:167], v[28:31], v[64:67]
    ds_read_b128 v[136:139], v73 offset:55296
    v_add_f32 v36, v36, v38
    v_add_f32 v37, v37, v39
    v_add_f32 v40, v40, v42
    v_add_f32 v41, v41, v43
    v_add_f32 v36, v36, v40
    v_add_f32 v37, v37, v41
    v_mfma_f32_16x16x32_bf16 v[68:71], v[168:171], v[28:31], v[68:71]
    ds_read_b128 v[140:143], v73 offset:56320
    s_waitcnt vmcnt(5)
    s_waitcnt lgkmcnt(7)
    v_mfma_f32_16x16x32_bf16 v[44:47], v[88:91], v[32:35], v[44:47]
    ds_read_b128 v[144:147], v73 offset:57344
    v_mfma_f32_16x16x32_bf16 v[48:51], v[92:95], v[32:35], v[48:51]
    ds_read_b128 v[148:151], v73 offset:58368
    s_add_u32 s54, s68, 19456
    buffer_load_dwordx4 v[16:19], v196, s[12:15], s54 offen sc1
    v_mfma_f32_16x16x32_bf16 v[52:55], v[96:99], v[32:35], v[52:55]
    ds_read_b128 v[152:155], v73 offset:59392
    v_mfma_f32_16x16x32_bf16 v[56:59], v[100:103], v[32:35], v[56:59]
    ds_read_b128 v[156:159], v73 offset:60416
    v_mfma_f32_16x16x32_bf16 v[60:63], v[104:107], v[32:35], v[60:63]
    ds_read_b128 v[160:163], v73 offset:61440
    v_mov_b32 v38, v36
    v_mov_b32 v39, v37
    s_nop 0
    v_permlane16_swap_b32 v36, v38
    v_permlane16_swap_b32 v37, v39
    s_nop 0
    v_add_f32 v36, v36, v38
    v_add_f32 v37, v37, v39
    v_mfma_f32_16x16x32_bf16 v[64:67], v[108:111], v[32:35], v[64:67]
    ds_read_b128 v[164:167], v73 offset:62464
    v_mfma_f32_16x16x32_bf16 v[68:71], v[112:115], v[32:35], v[68:71]
    ds_read_b128 v[168:171], v73 offset:63488
    s_waitcnt vmcnt(4)
    s_waitcnt lgkmcnt(7)
    v_mfma_f32_16x16x32_bf16 v[44:47], v[116:119], v[4:7], v[44:47]
    ds_read_b128 v[88:91], v74 offset:0
    v_mfma_f32_16x16x32_bf16 v[48:51], v[120:123], v[4:7], v[48:51]
    ds_read_b128 v[92:95], v74 offset:1024
    v_mov_b32 v38, v36
    v_mov_b32 v39, v37
    s_nop 0
    v_permlane32_swap_b32 v36, v38
    v_permlane32_swap_b32 v37, v39
    s_nop 0
    v_add_f32 v36, v36, v38
    v_add_f32 v37, v37, v39
    v_mfma_f32_16x16x32_bf16 v[52:55], v[124:127], v[4:7], v[52:55]
    ds_read_b128 v[96:99], v74 offset:2048
    v_mfma_f32_16x16x32_bf16 v[56:59], v[128:131], v[4:7], v[56:59]
    ds_read_b128 v[100:103], v74 offset:3072
    v_mfma_f32_16x16x32_bf16 v[60:63], v[132:135], v[4:7], v[60:63]
    ds_read_b128 v[104:107], v74 offset:4096
    v_mfma_f32_16x16x32_bf16 v[64:67], v[136:139], v[4:7], v[64:67]
    ds_read_b128 v[108:111], v74 offset:5120
    v_mfma_f32_16x16x32_bf16 v[68:71], v[140:143], v[4:7], v[68:71]
    ds_read_b128 v[112:115], v74 offset:6144
    s_waitcnt vmcnt(3)
    s_waitcnt lgkmcnt(7)
    v_mfma_f32_16x16x32_bf16 v[44:47], v[144:147], v[8:11], v[44:47]
    ds_read_b128 v[116:119], v74 offset:7168
    v_mfma_f32_16x16x32_bf16 v[48:51], v[148:151], v[8:11], v[48:51]
    ds_read_b128 v[120:123], v74 offset:8192
    s_add_u32 s54, s83, 203776
    buffer_load_dwordx4 v[248:251], v196, s[12:15], s54 offen sc1
    v_mfma_f32_16x16x32_bf16 v[52:55], v[152:155], v[8:11], v[52:55]
    ds_read_b128 v[124:127], v74 offset:9216
    v_mfma_f32_16x16x32_bf16 v[56:59], v[156:159], v[8:11], v[56:59]
    ds_read_b128 v[128:131], v74 offset:10240
    v_mfma_f32_16x16x32_bf16 v[60:63], v[160:163], v[8:11], v[60:63]
    ds_read_b128 v[132:135], v74 offset:11264
    v_mul_f32 v36, 0x3acccccd, v36
    v_mul_f32 v38, v36, v36
    v_mov_b32 v39, 0x3acccccd
    v_fma_f32 v38, v37, v39, -v38
    v_max_f32 v38, 0, v38
    v_add_f32 v38, 0x3727c5ac, v38
    v_rsq_f32 v37, v38
    v_mov_b32 v38, 0xbfb8aa3b
    s_mul_i32 s76, s74, 55296
    v_mul_f32 v37, v37, v38
    s_add_u32 s76, s76, 14680064
    v_mul_f32 v36, v36, v37
    s_lshr_b32 s55, s70, 3
    s_add_u32 s55, s55, s70
    s_mul_i32 s55, s55, 3072
    s_add_u32 s77, s55, s76
    v_mfma_f32_16x16x32_bf16 v[64:67], v[164:167], v[8:11], v[64:67]
    ds_read_b128 v[136:139], v74 offset:12288
    v_mfma_f32_16x16x32_bf16 v[68:71], v[168:171], v[8:11], v[68:71]
    ds_read_b128 v[140:143], v74 offset:13312
    s_waitcnt vmcnt(3)
    s_waitcnt lgkmcnt(7)
    v_mfma_f32_16x16x32_bf16 v[44:47], v[88:91], v[12:15], v[44:47]
    v_mfma_f32_16x16x32_bf16 v[48:51], v[92:95], v[12:15], v[48:51]
    s_lshr_b32 s56, s70, 1
    s_cmp_ge_u32 s70, 6
    s_cselect_b32 s55, 48, 24
    s_add_u32 s56, s56, s55
    s_lshl_b32 s56, s56, 10
    s_and_b32 s55, s70, 1
    s_lshl_b32 s55, s55, 9
    s_add_u32 s56, s56, s55
    s_add_u32 s76, s76, s56
    s_lshl_b32 s55, s71, 4
    s_add_u32 s55, s55, s70
    s_mul_i32 s57, s55, 128
    s_add_u32 s57, s57, 30539776
    v_mfma_f32_16x16x32_bf16 v[52:55], v[96:99], v[12:15], v[52:55]
    v_mfma_f32_16x16x32_bf16 v[56:59], v[100:103], v[12:15], v[56:59]
    v_mfma_f32_16x16x32_bf16 v[60:63], v[104:107], v[12:15], v[60:63]
    v_mfma_f32_16x16x32_bf16 v[64:67], v[108:111], v[12:15], v[64:67]
    v_mfma_f32_16x16x32_bf16 v[68:71], v[112:115], v[12:15], v[68:71]
    s_waitcnt vmcnt(1)
    s_waitcnt lgkmcnt(0)
    v_mfma_f32_16x16x32_bf16 v[44:47], v[116:119], v[16:19], v[44:47]
    v_mfma_f32_16x16x32_bf16 v[48:51], v[120:123], v[16:19], v[48:51]
    v_mfma_f32_16x16x32_bf16 v[52:55], v[124:127], v[16:19], v[52:55]
    v_mfma_f32_16x16x32_bf16 v[56:59], v[128:131], v[16:19], v[56:59]
    v_mfma_f32_16x16x32_bf16 v[60:63], v[132:135], v[16:19], v[60:63]
    v_mfma_f32_16x16x32_bf16 v[64:67], v[136:139], v[16:19], v[64:67]
    v_mfma_f32_16x16x32_bf16 v[68:71], v[140:143], v[16:19], v[68:71]
    ds_read_b128 v[144:147], v76 offset:0
    ds_read_b128 v[148:151], v76 offset:64
    ds_read_b128 v[152:155], v76 offset:128
    ds_read_b128 v[156:159], v76 offset:192
    ds_read_b128 v[160:163], v76 offset:256
    ds_read_b128 v[164:167], v76 offset:320
    ds_read_b128 v[168:171], v76 offset:384
    s_add_u32 s54, s83, 32768
    buffer_load_dwordx4 v[188:191], v196, s[12:15], s54 offen sc1
    s_add_u32 s54, s83, 40960
    buffer_load_dwordx4 v[192:195], v196, s[12:15], s54 offen sc1
    s_add_u32 s54, s83, 49152
    buffer_load_dwordx4 v[204:207], v196, s[12:15], s54 offen sc1
    s_cmp_lt_u32 s28, 4
    s_cbranch_scc1 L_p4_nb
    s_waitcnt lgkmcnt(0)
    s_barrier
L_p4_nb:
    s_waitcnt lgkmcnt(0)
    s_cmp_ge_u32 s70, 12
    s_cbranch_scc1 L_p4_no6
    v_mul_f32 v68, v37, v68
    v_mul_f32 v69, v37, v69
    v_mul_f32 v70, v37, v70
    v_mul_f32 v71, v37, v71
    v_fma_f32 v68, -v36, v168, v68
    v_fma_f32 v69, -v36, v169, v69
    v_fma_f32 v70, -v36, v170, v70
    v_fma_f32 v71, -v36, v171, v71
    v_exp_f32 v112, v68
    v_exp_f32 v113, v69
    v_exp_f32 v114, v70
    v_exp_f32 v115, v71
    v_fma_f32 v112, v112, v38, v38
    v_fma_f32 v113, v113, v38, v38
    v_fma_f32 v114, v114, v38, v38
    v_fma_f32 v115, v115, v38, v38
    v_rcp_f32 v112, v112
    v_rcp_f32 v113, v113
    v_rcp_f32 v114, v114
    v_rcp_f32 v115, v115
    v_mul_f32 v68, v68, v112
    v_mul_f32 v69, v69, v113
    v_mul_f32 v70, v70, v114
    v_mul_f32 v71, v71, v115
    v_cvt_pk_bf16_f32 v16, v68, v69
    v_cvt_pk_bf16_f32 v17, v70, v71
    v_mov_b32 v20, v16
    v_mov_b32 v21, v17
    v_mov_b32 v22, v16
    v_mov_b32 v23, v17
    s_nop 0
    v_permlane16_swap_b32 v20, v22
    v_permlane16_swap_b32 v21, v23
    s_mov_b32 exec_lo, 0xffff
    s_mov_b32 exec_hi, 0xffff
    buffer_store_dwordx4 v[20:23], v254, s[12:15], s76 offen sc1
    s_mov_b64 exec, -1
L_p4_no6:
    v_mul_f32 v44, v37, v44
    v_mul_f32 v45, v37, v45
    v_mul_f32 v46, v37, v46
    v_mul_f32 v47, v37, v47
    v_mul_f32 v48, v37, v48
    v_mul_f32 v49, v37, v49
    v_mul_f32 v50, v37, v50
    v_mul_f32 v51, v37, v51
    v_fma_f32 v44, -v36, v144, v44
    v_fma_f32 v45, -v36, v145, v45
    v_fma_f32 v46, -v36, v146, v46
    v_fma_f32 v47, -v36, v147, v47
    v_fma_f32 v48, -v36, v148, v48
    v_fma_f32 v49, -v36, v149, v49
    v_fma_f32 v50, -v36, v150, v50
    v_fma_f32 v51, -v36, v151, v51
    v_exp_f32 v88, v44
    v_exp_f32 v89, v45
    v_exp_f32 v90, v46
    v_exp_f32 v91, v47
    v_exp_f32 v92, v48
    v_exp_f32 v93, v49
    v_exp_f32 v94, v50
    v_exp_f32 v95, v51
    v_fma_f32 v88, v88, v38, v38
    v_fma_f32 v89, v89, v38, v38
    v_fma_f32 v90, v90, v38, v38
    v_fma_f32 v91, v91, v38, v38
    v_fma_f32 v92, v92, v38, v38
    v_fma_f32 v93, v93, v38, v38
    v_fma_f32 v94, v94, v38, v38
    v_fma_f32 v95, v95, v38, v38
    v_rcp_f32 v88, v88
    v_rcp_f32 v89, v89
    v_rcp_f32 v90, v90
    v_rcp_f32 v91, v91
    v_rcp_f32 v92, v92
    v_rcp_f32 v93, v93
    v_rcp_f32 v94, v94
    v_rcp_f32 v95, v95
    v_mul_f32 v44, v44, v88
    v_mul_f32 v45, v45, v89
    v_mul_f32 v46, v46, v90
    v_mul_f32 v47, v47, v91
    v_mul_f32 v48, v48, v92
    v_mul_f32 v49, v49, v93
    v_mul_f32 v50, v50, v94
    v_mul_f32 v51, v51, v95
    v_cvt_pk_bf16_f32 v4, v44, v45
    v_cvt_pk_bf16_f32 v5, v46, v47
    v_cvt_pk_bf16_f32 v6, v48, v49
    v_cvt_pk_bf16_f32 v7, v50, v51
    buffer_store_dwordx4 v[4:7], v196, s[12:15], s77 offen offset:0 sc1
    v_mul_f32 v52, v37, v52
    v_mul_f32 v53, v37, v53
    v_mul_f32 v54, v37, v54
    v_mul_f32 v55, v37, v55
    v_mul_f32 v56, v37, v56
    v_mul_f32 v57, v37, v57
    v_mul_f32 v58, v37, v58
    v_mul_f32 v59, v37, v59
    v_fma_f32 v52, -v36, v152, v52
    v_fma_f32 v53, -v36, v153, v53
    v_fma_f32 v54, -v36, v154, v54
    v_fma_f32 v55, -v36, v155, v55
    v_fma_f32 v56, -v36, v156, v56
    v_fma_f32 v57, -v36, v157, v57
    v_fma_f32 v58, -v36, v158, v58
    v_fma_f32 v59, -v36, v159, v59
    v_exp_f32 v96, v52
    v_exp_f32 v97, v53
    v_exp_f32 v98, v54
    v_exp_f32 v99, v55
    v_exp_f32 v100, v56
    v_exp_f32 v101, v57
    v_exp_f32 v102, v58
    v_exp_f32 v103, v59
    v_fma_f32 v96, v96, v38, v38
    v_fma_f32 v97, v97, v38, v38
    v_fma_f32 v98, v98, v38, v38
    v_fma_f32 v99, v99, v38, v38
    v_fma_f32 v100, v100, v38, v38
    v_fma_f32 v101, v101, v38, v38
    v_fma_f32 v102, v102, v38, v38
    v_fma_f32 v103, v103, v38, v38
    v_rcp_f32 v96, v96
    v_rcp_f32 v97, v97
    v_rcp_f32 v98, v98
    v_rcp_f32 v99, v99
    v_rcp_f32 v100, v100
    v_rcp_f32 v101, v101
    v_rcp_f32 v102, v102
    v_rcp_f32 v103, v103
    v_mul_f32 v52, v52, v96
    v_mul_f32 v53, v53, v97
    v_mul_f32 v54, v54, v98
    v_mul_f32 v55, v55, v99
    v_mul_f32 v56, v56, v100
    v_mul_f32 v57, v57, v101
    v_mul_f32 v58, v58, v102
    v_mul_f32 v59, v59, v103
    v_cvt_pk_bf16_f32 v8, v52, v53
    v_cvt_pk_bf16_f32 v9, v54, v55
    v_cvt_pk_bf16_f32 v10, v56, v57
    v_cvt_pk_bf16_f32 v11, v58, v59
    buffer_store_dwordx4 v[8:11], v196, s[12:15], s77 offen offset:1024 sc1
    v_mul_f32 v60, v37, v60
    v_mul_f32 v61, v37, v61
    v_mul_f32 v62, v37, v62
    v_mul_f32 v63, v37, v63
    v_mul_f32 v64, v37, v64
    v_mul_f32 v65, v37, v65
    v_mul_f32 v66, v37, v66
    v_mul_f32 v67, v37, v67
    v_fma_f32 v60, -v36, v160, v60
    v_fma_f32 v61, -v36, v161, v61
    v_fma_f32 v62, -v36, v162, v62
    v_fma_f32 v63, -v36, v163, v63
    v_fma_f32 v64, -v36, v164, v64
    v_fma_f32 v65, -v36, v165, v65
    v_fma_f32 v66, -v36, v166, v66
    v_fma_f32 v67, -v36, v167, v67
    v_exp_f32 v104, v60
    v_exp_f32 v105, v61
    v_exp_f32 v106, v62
    v_exp_f32 v107, v63
    v_exp_f32 v108, v64
    v_exp_f32 v109, v65
    v_exp_f32 v110, v66
    v_exp_f32 v111, v67
    v_fma_f32 v104, v104, v38, v38
    v_fma_f32 v105, v105, v38, v38
    v_fma_f32 v106, v106, v38, v38
    v_fma_f32 v107, v107, v38, v38
    v_fma_f32 v108, v108, v38, v38
    v_fma_f32 v109, v109, v38, v38
    v_fma_f32 v110, v110, v38, v38
    v_fma_f32 v111, v111, v38, v38
    v_rcp_f32 v104, v104
    v_rcp_f32 v105, v105
    v_rcp_f32 v106, v106
    v_rcp_f32 v107, v107
    v_rcp_f32 v108, v108
    v_rcp_f32 v109, v109
    v_rcp_f32 v110, v110
    v_rcp_f32 v111, v111
    v_mul_f32 v60, v60, v104
    v_mul_f32 v61, v61, v105
    v_mul_f32 v62, v62, v106
    v_mul_f32 v63, v63, v107
    v_mul_f32 v64, v64, v108
    v_mul_f32 v65, v65, v109
    v_mul_f32 v66, v66, v110
    v_mul_f32 v67, v67, v111
    v_cvt_pk_bf16_f32 v12, v60, v61
    v_cvt_pk_bf16_f32 v13, v62, v63
    v_cvt_pk_bf16_f32 v14, v64, v65
    v_cvt_pk_bf16_f32 v15, v66, v67
    buffer_store_dwordx4 v[12:15], v196, s[12:15], s77 offen offset:2048 sc1
    s_cmp_ge_u32 s28, 4
    s_cbranch_scc1 L_p4_y
    s_barrier
    s_waitcnt vmcnt(3)
    s_add_u32 m0, s73, 73728
    s_add_u32 s54, s83, 73728
    buffer_load_dwordx4 v196, s[12:15], s54 offen sc1 lds
    s_add_u32 m0, s73, 155648
    s_add_u32 s54, s83, 211968
    buffer_load_dwordx4 v196, s[12:15], s54 offen sc1 lds
    ds_write_b128 v1, v[172:175] offset:0
    ds_write_b128 v1, v[176:179] offset:8192
    ds_write_b128 v1, v[180:183] offset:16384
    ds_write_b128 v1, v[184:187] offset:24576
    ds_write_b128 v1, v[188:191] offset:32768
    s_waitcnt lgkmcnt(4)
    s_add_u32 s54, s83, 81920
    buffer_load_dwordx4 v[172:175], v196, s[12:15], s54 offen sc1
    ds_write_b128 v1, v[192:195] offset:40960
    s_waitcnt lgkmcnt(4)
    s_add_u32 s54, s83, 90112
    buffer_load_dwordx4 v[176:179], v196, s[12:15], s54 offen sc1
    ds_write_b128 v1, v[204:207] offset:49152
    s_waitcnt lgkmcnt(4)
    s_add_u32 s54, s83, 98304
    buffer_load_dwordx4 v[180:183], v196, s[12:15], s54 offen sc1
    ds_write_b128 v1, v[208:211] offset:57344
    s_waitcnt lgkmcnt(4)
    s_add_u32 s54, s83, 106496
    buffer_load_dwordx4 v[184:187], v196, s[12:15], s54 offen sc1
    ds_write_b128 v2, v[212:215] offset:0
    s_waitcnt lgkmcnt(4)
    s_add_u32 s54, s83, 114688
    buffer_load_dwordx4 v[188:191], v196, s[12:15], s54 offen sc1
    ds_write_b128 v2, v[216:219] offset:16384
    s_waitcnt lgkmcnt(4)
    s_add_u32 s54, s83, 122880
    buffer_load_dwordx4 v[192:195], v196, s[12:15], s54 offen sc1
    ds_write_b128 v2, v[220:223] offset:24576
    s_waitcnt lgkmcnt(4)
    s_add_u32 s54, s83, 131072
    buffer_load_dwordx4 v[204:207], v196, s[12:15], s54 offen sc1
    ds_write_b128 v2, v[224:227] offset:32768
    ds_write_b128 v2, v[228:231] offset:40960
    ds_write_b128 v2, v[232:235] offset:49152
    ds_write_b128 v2, v[236:239] offset:57344
    ds_write_b128 v3, v[240:243] offset:0
    ds_write_b128 v3, v[244:247] offset:8192
    ds_write_b128 v3, v[248:251] offset:16384
    v_mov_b32 v80, s32
    v_mov_b32 v81, s33
    v_mov_b32 v82, 0
    s_waitcnt vmcnt(9)
    s_barrier
    s_cmp_lg_u32 s28, 0
    s_cbranch_scc1 L_nofl_38
    s_mov_b64 exec, 1
    buffer_store_dwordx2 v[80:81], v82, s[12:15], s57 offen sc1
    s_mov_b64 exec, -1
L_nofl_38:
    s_branch L_p4_e
L_p4_y:
    s_waitcnt vmcnt(3)
    ds_write_b128 v1, v[172:175] offset:0
    ds_write_b128 v1, v[176:179] offset:8192
    ds_write_b128 v1, v[180:183] offset:16384
    ds_write_b128 v1, v[184:187] offset:24576
    ds_write_b128 v1, v[188:191] offset:32768
    ds_write_b128 v1, v[192:195] offset:40960
    ds_write_b128 v1, v[204:207] offset:49152
    ds_write_b128 v1, v[208:211] offset:57344
    ds_write_b128 v2, v[212:215] offset:0
    ds_write_b128 v2, v[216:219] offset:16384
    ds_write_b128 v2, v[220:223] offset:24576
    ds_write_b128 v2, v[224:227] offset:32768
    ds_write_b128 v2, v[228:231] offset:40960
    ds_write_b128 v2, v[232:235] offset:49152
    ds_write_b128 v2, v[236:239] offset:57344
    ds_write_b128 v3, v[240:243] offset:0
    ds_write_b128 v3, v[244:247] offset:8192
    ds_write_b128 v3, v[248:251] offset:16384
    s_waitcnt vmcnt(0)
    s_barrier
    s_add_u32 m0, s73, 73728
    s_add_u32 s54, s83, 73728
    buffer_load_dwordx4 v196, s[12:15], s54 offen sc1 lds
    s_add_u32 m0, s73, 155648
    s_add_u32 s54, s83, 211968
    buffer_load_dwordx4 v196, s[12:15], s54 offen sc1 lds
    s_waitcnt lgkmcnt(11)
    s_add_u32 s54, s83, 81920
    buffer_load_dwordx4 v[172:175], v196, s[12:15], s54 offen sc1
    s_add_u32 s54, s83, 90112
    buffer_load_dwordx4 v[176:179], v196, s[12:15], s54 offen sc1
    s_add_u32 s54, s83, 98304
    buffer_load_dwordx4 v[180:183], v196, s[12:15], s54 offen sc1
    s_add_u32 s54, s83, 106496
    buffer_load_dwordx4 v[184:187], v196, s[12:15], s54 offen sc1
    s_add_u32 s54, s83, 114688
    buffer_load_dwordx4 v[188:191], v196, s[12:15], s54 offen sc1
    s_add_u32 s54, s83, 122880
    buffer_load_dwordx4 v[192:195], v196, s[12:15], s54 offen sc1
    s_add_u32 s54, s83, 131072
    buffer_load_dwordx4 v[204:207], v196, s[12:15], s54 offen sc1
L_p4_e:
    s_mul_i32 s54, s65, 81920
    s_lshl_b32 s55, s65, 11
    v_add_u32 v74, s54, v196
    v_add_u32 v72, s55, v74
    v_subrev_u32 v73, s55, v74
    v_add_u32 v75, 61440, v72
    v_add_u32 v76, 61440, v73
    v_add_u32 v77, 61440, v74
    v_and_b32 v84, 15, v0
    s_lshl_b32 s54, s64, 4
    v_add_u32 v84, s54, v84
    v_mul_u32_u24 v84, 336, v84
    v_lshrrev_b32 v85, 4, v0
    v_lshl_add_u32 v84, v85, 4, v84
    s_mul_i32 s54, s65, 81920
    s_add_u32 s54, s54, 56320
    v_add_u32 v252, s54, v84
    s_lshl_b32 s54, s65, 7
    v_add_u32 v78, s54, v252
    v_subrev_u32 v79, s54, v252
    s_mul_i32 s54, s28, 0x50
    s_add_u32 s54, s54, 0
    v_add_u32 v82, s54, v0
    v_mul_u32_u24 v83, 6554, v82
    v_lshrrev_b32 v83, 16, v83
    v_mul_u32_u24 v84, 10, v83
    v_sub_u32 v82, v82, v84
    v_mul_u32_u24 v84, 336, v83
    v_lshl_add_u32 v84, v82, 5, v84
    v_add_u32 v84, 56320, v84
    v_mul_u32_u24 v85, 1280, v83
    v_lshl_add_u32 v85, v82, 4, v85
    s_mul_i32 s54, s28, 0x50
    s_add_u32 s54, s54, 64
    v_add_u32 v82, s54, v0
    v_mul_u32_u24 v83, 6554, v82
    v_lshrrev_b32 v83, 16, v83
    v_mul_u32_u24 v86, 10, v83
    v_sub_u32 v82, v82, v86
    v_mul_u32_u24 v86, 336, v83
    v_lshl_add_u32 v86, v82, 5, v86
    v_add_u32 v86, 56320, v86
    v_mul_u32_u24 v87, 1280, v83
    v_lshl_add_u32 v87, v82, 4, v87
    s_mul_i32 s68, s67, 81920
    s_mul_i32 s54, s66, 160
    s_add_u32 s68, s68, s54
    s_mul_i32 s69, s81, 55296
    s_mul_i32 s55, s65, 27648
    s_add_u32 s69, s69, s55
    s_add_u32 s69, s69, 14680064
    s_sub_u32 s54, s65, 1
    v_lshlrev_b32 v44, 16, v198
    v_and_b32 v45, 0xffff0000, v198
    v_lshlrev_b32 v46, 16, v199
    v_and_b32 v47, 0xffff0000, v199
    v_lshlrev_b32 v48, 16, v200
    v_and_b32 v49, 0xffff0000, v200
    v_lshlrev_b32 v50, 16, v201
    v_and_b32 v51, 0xffff0000, v201
    v_and_b32 v82, s54, v202
    v_lshlrev_b32 v60, 16, v82
    v_and_b32 v61, 0xffff0000, v82
    v_and_b32 v82, s54, v203
    v_lshlrev_b32 v62, 16, v82
    v_and_b32 v63, 0xffff0000, v82
    v_mov_b32 v52, 0
    v_mov_b32 v53, 0
    v_mov_b32 v54, 0
    v_mov_b32 v55, 0
    v_mov_b32 v56, 0
    v_mov_b32 v57, 0
    v_mov_b32 v58, 0
    v_mov_b32 v59, 0
    s_lshr_b32 s57, s67, 1
    s_mul_i32 s57, s57, 2048
    s_add_u32 s57, s57, 30539776
    s_cmp_lg_u32 s28, 0
    s_cbranch_scc1 L_polld_40
    s_mov_b32 s62, 0
    v_and_b32 v82, 15, v0
    v_mul_u32_u24 v82, 128, v82
L_poll_39:
    buffer_load_dwordx2 v[80:81], v82, s[12:15], s57 offen sc1
    s_add_u32 s62, s62, 1
    s_waitcnt vmcnt(0)
    v_cmp_ne_u64 vcc, s[32:33], v[80:81]
    s_nop 0
    s_or_b64 s[58:59], vcc, vcc
    s_cbranch_scc0 L_polld_40
    s_cmp_lt_u32 s62, 200000
    s_cbranch_scc1 L_poll_39
L_polld_40:
    s_waitcnt lgkmcnt(0)
    s_barrier
    s_add_u32 s54, s69, 0
    buffer_load_dwordx4 v[4:7], v196, s[12:15], s54 offen sc1
    s_add_u32 s54, s69, 1024
    buffer_load_dwordx4 v[8:11], v196, s[12:15], s54 offen sc1
    s_add_u32 s54, s69, 2048
    buffer_load_dwordx4 v[12:15], v196, s[12:15], s54 offen sc1
    s_add_u32 s54, s69, 3072
    buffer_load_dwordx4 v[16:19], v196, s[12:15], s54 offen sc1
    s_add_u32 s54, s69, 4096
    buffer_load_dwordx4 v[20:23], v196, s[12:15], s54 offen sc1
    s_add_u32 s54, s69, 5120
    buffer_load_dwordx4 v[24:27], v196, s[12:15], s54 offen sc1
    ds_read_b128 v[88:91], v72 offset:0
    ds_read_b128 v[92:95], v72 offset:1024
    ds_read_b128 v[96:99], v73 offset:2048
    ds_read_b128 v[100:103], v73 offset:3072
    ds_read_b128 v[104:107], v74 offset:4096
    ds_read_b128 v[108:111], v72 offset:5120
    ds_read_b128 v[112:115], v72 offset:6144
    ds_read_b128 v[116:119], v73 offset:7168
    ds_read_b128 v[120:123], v73 offset:8192
    ds_read_b128 v[124:127], v74 offset:9216
    s_waitcnt vmcnt(5)
    s_waitcnt lgkmcnt(5)
    v_mfma_f32_16x16x32_bf16 v[44:47], v[88:91], v[4:7], v[44:47]
    ds_read_b128 v[128:131], v72 offset:10240
    v_mfma_f32_16x16x32_bf16 v[48:51], v[92:95], v[4:7], v[48:51]
    ds_read_b128 v[132:135], v72 offset:11264
    s_add_u32 s54, s69, 6144
    buffer_load_dwordx4 v[28:31], v196, s[12:15], s54 offen sc1
    v_mfma_f32_16x16x32_bf16 v[52:55], v[96:99], v[4:7], v[52:55]
    ds_read_b128 v[136:139], v73 offset:12288
    v_mfma_f32_16x16x32_bf16 v[56:59], v[100:103], v[4:7], v[56:59]
    ds_read_b128 v[140:143], v73 offset:13312
    v_mfma_f32_16x16x32_bf16 v[60:63], v[104:107], v[4:7], v[60:63]
    ds_read_b128 v[144:147], v74 offset:14336
    s_waitcnt vmcnt(5)
    s_waitcnt lgkmcnt(5)
    v_mfma_f32_16x16x32_bf16 v[44:47], v[108:111], v[8:11], v[44:47]
    ds_read_b128 v[88:91], v72 offset:15360
    v_mfma_f32_16x16x32_bf16 v[48:51], v[112:115], v[8:11], v[48:51]
    ds_read_b128 v[92:95], v72 offset:16384
    s_add_u32 s54, s69, 7168
    buffer_load_dwordx4 v[32:35], v196, s[12:15], s54 offen sc1
    v_mfma_f32_16x16x32_bf16 v[52:55], v[116:119], v[8:11], v[52:55]
    ds_read_b128 v[96:99], v73 offset:17408
    v_mfma_f32_16x16x32_bf16 v[56:59], v[120:123], v[8:11], v[56:59]
    ds_read_b128 v[100:103], v73 offset:18432
    v_mfma_f32_16x16x32_bf16 v[60:63], v[124:127], v[8:11], v[60:63]
    ds_read_b128 v[104:107], v74 offset:19456
    s_waitcnt vmcnt(5)
    s_waitcnt lgkmcnt(5)
    v_mfma_f32_16x16x32_bf16 v[44:47], v[128:131], v[12:15], v[44:47]
    ds_read_b128 v[108:111], v72 offset:20480
    v_mfma_f32_16x16x32_bf16 v[48:51], v[132:135], v[12:15], v[48:51]
    ds_read_b128 v[112:115], v72 offset:21504
    s_add_u32 s54, s69, 8192
    buffer_load_dwordx4 v[4:7], v196, s[12:15], s54 offen sc1
    v_mfma_f32_16x16x32_bf16 v[52:55], v[136:139], v[12:15], v[52:55]
    ds_read_b128 v[116:119], v73 offset:22528
    v_mfma_f32_16x16x32_bf16 v[56:59], v[140:143], v[12:15], v[56:59]
    ds_read_b128 v[120:123], v73 offset:23552
    v_mfma_f32_16x16x32_bf16 v[60:63], v[144:147], v[12:15], v[60:63]
    ds_read_b128 v[124:127], v74 offset:24576
    s_waitcnt vmcnt(5)
    s_waitcnt lgkmcnt(5)
    v_mfma_f32_16x16x32_bf16 v[44:47], v[88:91], v[16:19], v[44:47]
    ds_read_b128 v[128:131], v72 offset:25600
    v_mfma_f32_16x16x32_bf16 v[48:51], v[92:95], v[16:19], v[48:51]
    ds_read_b128 v[132:135], v72 offset:26624
    s_add_u32 s54, s69, 9216
    buffer_load_dwordx4 v[8:11], v196, s[12:15], s54 offen sc1
    v_mfma_f32_16x16x32_bf16 v[52:55], v[96:99], v[16:19], v[52:55]
    ds_read_b128 v[136:139], v73 offset:27648
    v_mfma_f32_16x16x32_bf16 v[56:59], v[100:103], v[16:19], v[56:59]
    ds_read_b128 v[140:143], v73 offset:28672
    v_mfma_f32_16x16x32_bf16 v[60:63], v[104:107], v[16:19], v[60:63]
    ds_read_b128 v[144:147], v74 offset:29696
    s_waitcnt vmcnt(5)
    s_waitcnt lgkmcnt(5)
    v_mfma_f32_16x16x32_bf16 v[44:47], v[108:111], v[20:23], v[44:47]
    ds_read_b128 v[88:91], v72 offset:30720
    v_mfma_f32_16x16x32_bf16 v[48:51], v[112:115], v[20:23], v[48:51]
    ds_read_b128 v[92:95], v72 offset:31744
    s_add_u32 s54, s69, 10240
    buffer_load_dwordx4 v[12:15], v196, s[12:15], s54 offen sc1
    v_mfma_f32_16x16x32_bf16 v[52:55], v[116:119], v[20:23], v[52:55]
    ds_read_b128 v[96:99], v73 offset:32768
    v_mfma_f32_16x16x32_bf16 v[56:59], v[120:123], v[20:23], v[56:59]
    ds_read_b128 v[100:103], v73 offset:33792
    v_mfma_f32_16x16x32_bf16 v[60:63], v[124:127], v[20:23], v[60:63]
    ds_read_b128 v[104:107], v74 offset:34816
    s_barrier
    s_waitcnt vmcnt(5)
    s_waitcnt lgkmcnt(5)
    v_mfma_f32_16x16x32_bf16 v[44:47], v[128:131], v[24:27], v[44:47]
    ds_read_b128 v[108:111], v72 offset:35840
    v_mfma_f32_16x16x32_bf16 v[48:51], v[132:135], v[24:27], v[48:51]
    ds_read_b128 v[112:115], v72 offset:36864
    s_add_u32 s54, s69, 11264
    buffer_load_dwordx4 v[16:19], v196, s[12:15], s54 offen sc1
    v_mfma_f32_16x16x32_bf16 v[52:55], v[136:139], v[24:27], v[52:55]
    ds_read_b128 v[116:119], v73 offset:37888
    v_mfma_f32_16x16x32_bf16 v[56:59], v[140:143], v[24:27], v[56:59]
    ds_read_b128 v[120:123], v73 offset:38912
    s_add_u32 m0, s73, 81920
    s_add_u32 s54, s83, 220160
    buffer_load_dwordx4 v196, s[12:15], s54 offen sc1 lds
    ds_write_b128 v1, v[172:175] offset:0
    v_mfma_f32_16x16x32_bf16 v[60:63], v[144:147], v[24:27], v[60:63]
    ds_read_b128 v[124:127], v74 offset:39936
    s_waitcnt vmcnt(6)
    s_waitcnt lgkmcnt(6)
    v_mfma_f32_16x16x32_bf16 v[44:47], v[88:91], v[28:31], v[44:47]
    ds_read_b128 v[128:131], v72 offset:40960
    v_mfma_f32_16x16x32_bf16 v[48:51], v[92:95], v[28:31], v[48:51]
    ds_read_b128 v[132:135], v72 offset:41984
    s_add_u32 s54, s69, 12288
    buffer_load_dwordx4 v[20:23], v196, s[12:15], s54 offen sc1
    v_mfma_f32_16x16x32_bf16 v[52:55], v[96:99], v[28:31], v[52:55]
    ds_read_b128 v[136:139], v73 offset:43008
    v_mfma_f32_16x16x32_bf16 v[56:59], v[100:103], v[28:31], v[56:59]
    ds_read_b128 v[140:143], v73 offset:44032
    s_add_u32 m0, s73, 90112
    s_add_u32 s54, s83, 228352
    buffer_load_dwordx4 v196, s[12:15], s54 offen sc1 lds
    ds_write_b128 v1, v[176:179] offset:8192
    v_mfma_f32_16x16x32_bf16 v[60:63], v[104:107], v[28:31], v[60:63]
    ds_read_b128 v[144:147], v74 offset:45056
    s_waitcnt vmcnt(7)
    s_waitcnt lgkmcnt(6)
    v_mfma_f32_16x16x32_bf16 v[44:47], v[108:111], v[32:35], v[44:47]
    ds_read_b128 v[88:91], v72 offset:46080
    v_mfma_f32_16x16x32_bf16 v[48:51], v[112:115], v[32:35], v[48:51]
    ds_read_b128 v[92:95], v72 offset:47104
    s_add_u32 s54, s69, 13312
    buffer_load_dwordx4 v[24:27], v196, s[12:15], s54 offen sc1
    v_mfma_f32_16x16x32_bf16 v[52:55], v[116:119], v[32:35], v[52:55]
    ds_read_b128 v[96:99], v73 offset:48128
    v_mfma_f32_16x16x32_bf16 v[56:59], v[120:123], v[32:35], v[56:59]
    ds_read_b128 v[100:103], v73 offset:49152
    s_add_u32 m0, s73, 98304
    s_add_u32 s54, s83, 236544
    buffer_load_dwordx4 v196, s[12:15], s54 offen sc1 lds
    ds_write_b128 v1, v[180:183] offset:16384
    v_mfma_f32_16x16x32_bf16 v[60:63], v[124:127], v[32:35], v[60:63]
    ds_read_b128 v[104:107], v74 offset:50176
    s_waitcnt vmcnt(8)
    s_waitcnt lgkmcnt(6)
    v_mfma_f32_16x16x32_bf16 v[44:47], v[128:131], v[4:7], v[44:47]
    ds_read_b128 v[108:111], v72 offset:51200
    v_mfma_f32_16x16x32_bf16 v[48:51], v[132:135], v[4:7], v[48:51]
    ds_read_b128 v[112:115], v72 offset:52224
    s_add_u32 s54, s69, 14336
    buffer_load_dwordx4 v[28:31], v196, s[12:15], s54 offen sc1
    v_mfma_f32_16x16x32_bf16 v[52:55], v[136:139], v[4:7], v[52:55]
    ds_read_b128 v[116:119], v73 offset:53248
    v_mfma_f32_16x16x32_bf16 v[56:59], v[140:143], v[4:7], v[56:59]
    ds_read_b128 v[120:123], v73 offset:54272
    v_mfma_f32_16x16x32_bf16 v[60:63], v[144:147], v[4:7], v[60:63]
    ds_read_b128 v[124:127], v74 offset:55296
    s_waitcnt vmcnt(8)
    s_waitcnt lgkmcnt(5)
    v_mfma_f32_16x16x32_bf16 v[44:47], v[88:91], v[8:11], v[44:47]
    ds_read_b128 v[128:131], v72 offset:56320
    v_mfma_f32_16x16x32_bf16 v[48:51], v[92:95], v[8:11], v[48:51]
    ds_read_b128 v[132:135], v72 offset:57344
    s_add_u32 s54, s69, 15360
    buffer_load_dwordx4 v[32:35], v196, s[12:15], s54 offen sc1
    v_mfma_f32_16x16x32_bf16 v[52:55], v[96:99], v[8:11], v[52:55]
    ds_read_b128 v[136:139], v73 offset:58368
    v_mfma_f32_16x16x32_bf16 v[56:59], v[100:103], v[8:11], v[56:59]
    ds_read_b128 v[140:143], v73 offset:59392
    v_mfma_f32_16x16x32_bf16 v[60:63], v[104:107], v[8:11], v[60:63]
    ds_read_b128 v[144:147], v74 offset:60416
    s_barrier
    s_waitcnt vmcnt(8)
    s_waitcnt lgkmcnt(5)
    v_mfma_f32_16x16x32_bf16 v[44:47], v[108:111], v[12:15], v[44:47]
    ds_read_b128 v[88:91], v75 offset:0
    v_mfma_f32_16x16x32_bf16 v[48:51], v[112:115], v[12:15], v[48:51]
    ds_read_b128 v[92:95], v75 offset:1024
    s_add_u32 s54, s69, 16384
    buffer_load_dwordx4 v[4:7], v196, s[12:15], s54 offen sc1
    v_mfma_f32_16x16x32_bf16 v[52:55], v[116:119], v[12:15], v[52:55]
    ds_read_b128 v[96:99], v76 offset:2048
    v_mfma_f32_16x16x32_bf16 v[56:59], v[120:123], v[12:15], v[56:59]
    ds_read_b128 v[100:103], v76 offset:3072
    s_add_u32 m0, s73, 106496
    s_add_u32 s54, s83, 244736
    buffer_load_dwordx4 v196, s[12:15], s54 offen sc1 lds
    ds_write_b128 v1, v[184:187] offset:24576
    v_mfma_f32_16x16x32_bf16 v[60:63], v[124:127], v[12:15], v[60:63]
    ds_read_b128 v[104:107], v77 offset:4096
    s_waitcnt vmcnt(9)
    s_waitcnt lgkmcnt(6)
    v_mfma_f32_16x16x32_bf16 v[44:47], v[128:131], v[16:19], v[44:47]
    ds_read_b128 v[108:111], v75 offset:5120
    v_mfma_f32_16x16x32_bf16 v[48:51], v[132:135], v[16:19], v[48:51]
    ds_read_b128 v[112:115], v75 offset:6144
    s_add_u32 s54, s69, 17408
    buffer_load_dwordx4 v[8:11], v196, s[12:15], s54 offen sc1
    v_mfma_f32_16x16x32_bf16 v[52:55], v[136:139], v[16:19], v[52:55]
    ds_read_b128 v[116:119], v76 offset:7168
    v_mfma_f32_16x16x32_bf16 v[56:59], v[140:143], v[16:19], v[56:59]
    ds_read_b128 v[120:123], v76 offset:8192
    s_add_u32 m0, s73, 114688
    s_add_u32 s54, s83, 252928
    buffer_load_dwordx4 v196, s[12:15], s54 offen sc1 lds
    ds_write_b128 v1, v[188:191] offset:32768
    v_mfma_f32_16x16x32_bf16 v[60:63], v[144:147], v[16:19], v[60:63]
    ds_read_b128 v[124:127], v77 offset:9216
    s_waitcnt vmcnt(9)
    s_waitcnt lgkmcnt(6)
    v_mfma_f32_16x16x32_bf16 v[44:47], v[88:91], v[20:23], v[44:47]
    ds_read_b128 v[128:131], v75 offset:10240
    v_mfma_f32_16x16x32_bf16 v[48:51], v[92:95], v[20:23], v[48:51]
    ds_read_b128 v[132:135], v75 offset:11264
    s_add_u32 s54, s69, 18432
    buffer_load_dwordx4 v[12:15], v196, s[12:15], s54 offen sc1
    v_mfma_f32_16x16x32_bf16 v[52:55], v[96:99], v[20:23], v[52:55]
    ds_read_b128 v[136:139], v76 offset:12288
    v_mfma_f32_16x16x32_bf16 v[56:59], v[100:103], v[20:23], v[56:59]
    ds_read_b128 v[140:143], v76 offset:13312
    s_add_u32 m0, s73, 122880
    s_add_u32 s54, s83, 261120
    buffer_load_dwordx4 v196, s[12:15], s54 offen sc1 lds
    ds_write_b128 v1, v[192:195] offset:40960
    v_mfma_f32_16x16x32_bf16 v[60:63], v[104:107], v[20:23], v[60:63]
    ds_read_b128 v[144:147], v77 offset:14336
    s_waitcnt vmcnt(9)
    s_waitcnt lgkmcnt(6)
    v_mfma_f32_16x16x32_bf16 v[44:47], v[108:111], v[24:27], v[44:47]
    ds_read_b128 v[88:91], v75 offset:15360
    v_mfma_f32_16x16x32_bf16 v[48:51], v[112:115], v[24:27], v[48:51]
    ds_read_b128 v[92:95], v75 offset:16384
    s_add_u32 s54, s69, 19456
    buffer_load_dwordx4 v[16:19], v196, s[12:15], s54 offen sc1
    v_mfma_f32_16x16x32_bf16 v[52:55], v[116:119], v[24:27], v[52:55]
    ds_read_b128 v[96:99], v76 offset:17408
    v_mfma_f32_16x16x32_bf16 v[56:59], v[120:123], v[24:27], v[56:59]
    ds_read_b128 v[100:103], v76 offset:18432
    v_mfma_f32_16x16x32_bf16 v[60:63], v[124:127], v[24:27], v[60:63]
    ds_read_b128 v[104:107], v77 offset:19456
    s_waitcnt lgkmcnt(6)
    s_waitcnt vmcnt(5)
    s_barrier
    s_waitcnt lgkmcnt(5)
    v_mfma_f32_16x16x32_bf16 v[44:47], v[128:131], v[28:31], v[44:47]
    ds_read_b128 v[108:111], v72 offset:0
    v_mfma_f32_16x16x32_bf16 v[48:51], v[132:135], v[28:31], v[48:51]
    ds_read_b128 v[112:115], v72 offset:1024
    s_add_u32 s54, s69, 20480
    buffer_load_dwordx4 v[20:23], v196, s[12:15], s54 offen sc1
    v_mfma_f32_16x16x32_bf16 v[52:55], v[136:139], v[28:31], v[52:55]
    ds_read_b128 v[116:119], v73 offset:2048
    v_mfma_f32_16x16x32_bf16 v[56:59], v[140:143], v[28:31], v[56:59]
    ds_read_b128 v[120:123], v73 offset:3072
    s_add_u32 m0, s73, 131072
    s_add_u32 s54, s83, 269312
    buffer_load_dwordx4 v196, s[12:15], s54 offen sc1 lds
    ds_write_b128 v1, v[204:207] offset:49152
    v_mfma_f32_16x16x32_bf16 v[60:63], v[144:147], v[28:31], v[60:63]
    ds_read_b128 v[124:127], v74 offset:4096
    s_waitcnt lgkmcnt(6)
    v_mfma_f32_16x16x32_bf16 v[44:47], v[88:91], v[32:35], v[44:47]
    ds_read_b128 v[128:131], v72 offset:5120
    v_mfma_f32_16x16x32_bf16 v[48:51], v[92:95], v[32:35], v[48:51]
    ds_read_b128 v[132:135], v72 offset:6144
    s_add_u32 s54, s69, 21504
    buffer_load_dwordx4 v[24:27], v196, s[12:15], s54 offen sc1
    v_mfma_f32_16x16x32_bf16 v[52:55], v[96:99], v[32:35], v[52:55]
    ds_read_b128 v[136:139], v73 offset:7168
    v_mfma_f32_16x16x32_bf16 v[56:59], v[100:103], v[32:35], v[56:59]
    ds_read_b128 v[140:143], v73 offset:8192
    v_mfma_f32_16x16x32_bf16 v[60:63], v[104:107], v[32:35], v[60:63]
    ds_read_b128 v[144:147], v74 offset:9216
    s_waitcnt lgkmcnt(5)
    v_mfma_f32_16x16x32_bf16 v[44:47], v[108:111], v[4:7], v[44:47]
    ds_read_b128 v[88:91], v72 offset:10240
    v_mfma_f32_16x16x32_bf16 v[48:51], v[112:115], v[4:7], v[48:51]
    ds_read_b128 v[92:95], v72 offset:11264
    s_add_u32 s54, s69, 22528
    buffer_load_dwordx4 v[28:31], v196, s[12:15], s54 offen sc1
    v_mfma_f32_16x16x32_bf16 v[52:55], v[116:119], v[4:7], v[52:55]
    ds_read_b128 v[96:99], v73 offset:12288
    v_mfma_f32_16x16x32_bf16 v[56:59], v[120:123], v[4:7], v[56:59]
    ds_read_b128 v[100:103], v73 offset:13312
    v_mfma_f32_16x16x32_bf16 v[60:63], v[124:127], v[4:7], v[60:63]
    ds_read_b128 v[104:107], v74 offset:14336
    s_waitcnt vmcnt(8)
    s_waitcnt lgkmcnt(5)
    v_mfma_f32_16x16x32_bf16 v[44:47], v[128:131], v[8:11], v[44:47]
    ds_read_b128 v[108:111], v72 offset:15360
    v_mfma_f32_16x16x32_bf16 v[48:51], v[132:135], v[8:11], v[48:51]
    ds_read_b128 v[112:115], v72 offset:16384
    s_add_u32 s54, s69, 23552
    buffer_load_dwordx4 v[32:35], v196, s[12:15], s54 offen sc1
    v_mfma_f32_16x16x32_bf16 v[52:55], v[136:139], v[8:11], v[52:55]
    ds_read_b128 v[116:119], v73 offset:17408
    v_mfma_f32_16x16x32_bf16 v[56:59], v[140:143], v[8:11], v[56:59]
    ds_read_b128 v[120:123], v73 offset:18432
    v_mfma_f32_16x16x32_bf16 v[60:63], v[144:147], v[8:11], v[60:63]
    ds_read_b128 v[124:127], v74 offset:19456
    s_waitcnt vmcnt(7)
    s_waitcnt lgkmcnt(5)
    v_mfma_f32_16x16x32_bf16 v[44:47], v[88:91], v[12:15], v[44:47]
    ds_read_b128 v[128:131], v72 offset:20480
    v_mfma_f32_16x16x32_bf16 v[48:51], v[92:95], v[12:15], v[48:51]
    ds_read_b128 v[132:135], v72 offset:21504
    s_add_u32 s54, s69, 24576
    buffer_load_dwordx4 v[4:7], v196, s[12:15], s54 offen sc1
    v_mfma_f32_16x16x32_bf16 v[52:55], v[96:99], v[12:15], v[52:55]
    ds_read_b128 v[136:139], v73 offset:22528
    v_mfma_f32_16x16x32_bf16 v[56:59], v[100:103], v[12:15], v[56:59]
    ds_read_b128 v[140:143], v73 offset:23552
    v_mfma_f32_16x16x32_bf16 v[60:63], v[104:107], v[12:15], v[60:63]
    ds_read_b128 v[144:147], v74 offset:24576
    s_waitcnt vmcnt(4)
    s_barrier
    s_waitcnt lgkmcnt(5)
    v_mfma_f32_16x16x32_bf16 v[44:47], v[108:111], v[16:19], v[44:47]
    ds_read_b128 v[88:91], v72 offset:25600
    v_mfma_f32_16x16x32_bf16 v[48:51], v[112:115], v[16:19], v[48:51]
    ds_read_b128 v[92:95], v72 offset:26624
    s_add_u32 s54, s69, 25600
    buffer_load_dwordx4 v[8:11], v196, s[12:15], s54 offen sc1
    v_mfma_f32_16x16x32_bf16 v[52:55], v[116:119], v[16:19], v[52:55]
    ds_read_b128 v[96:99], v73 offset:27648
    v_mfma_f32_16x16x32_bf16 v[56:59], v[120:123], v[16:19], v[56:59]
    ds_read_b128 v[100:103], v73 offset:28672
    v_mfma_f32_16x16x32_bf16 v[60:63], v[124:127], v[16:19], v[60:63]
    ds_read_b128 v[104:107], v74 offset:29696
    s_waitcnt lgkmcnt(5)
    v_mfma_f32_16x16x32_bf16 v[44:47], v[128:131], v[20:23], v[44:47]
    ds_read_b128 v[108:111], v72 offset:30720
    v_mfma_f32_16x16x32_bf16 v[48:51], v[132:135], v[20:23], v[48:51]
    ds_read_b128 v[112:115], v72 offset:31744
    s_add_u32 s54, s69, 26624
    buffer_load_dwordx4 v[12:15], v196, s[12:15], s54 offen sc1
    v_mfma_f32_16x16x32_bf16 v[52:55], v[136:139], v[20:23], v[52:55]
    ds_read_b128 v[116:119], v73 offset:32768
    v_mfma_f32_16x16x32_bf16 v[56:59], v[140:143], v[20:23], v[56:59]
    ds_read_b128 v[120:123], v73 offset:33792
    v_mfma_f32_16x16x32_bf16 v[60:63], v[144:147], v[20:23], v[60:63]
    ds_read_b128 v[124:127], v74 offset:34816
    s_waitcnt vmcnt(5)
    s_waitcnt lgkmcnt(5)
    v_mfma_f32_16x16x32_bf16 v[44:47], v[88:91], v[24:27], v[44:47]
    ds_read_b128 v[128:131], v72 offset:35840
    v_mfma_f32_16x16x32_bf16 v[48:51], v[92:95], v[24:27], v[48:51]
    ds_read_b128 v[132:135], v72 offset:36864
    v_mfma_f32_16x16x32_bf16 v[52:55], v[96:99], v[24:27], v[52:55]
    ds_read_b128 v[136:139], v73 offset:37888
    v_mfma_f32_16x16x32_bf16 v[56:59], v[100:103], v[24:27], v[56:59]
    ds_read_b128 v[140:143], v73 offset:38912
    v_mfma_f32_16x16x32_bf16 v[60:63], v[104:107], v[24:27], v[60:63]
    ds_read_b128 v[144:147], v74 offset:39936
    s_waitcnt vmcnt(4)
    s_waitcnt lgkmcnt(5)
    v_mfma_f32_16x16x32_bf16 v[44:47], v[108:111], v[28:31], v[44:47]
    ds_read_b128 v[88:91], v72 offset:40960
    v_mfma_f32_16x16x32_bf16 v[48:51], v[112:115], v[28:31], v[48:51]
    ds_read_b128 v[92:95], v72 offset:41984
    v_mfma_f32_16x16x32_bf16 v[52:55], v[116:119], v[28:31], v[52:55]
    ds_read_b128 v[96:99], v73 offset:43008
    v_mfma_f32_16x16x32_bf16 v[56:59], v[120:123], v[28:31], v[56:59]
    ds_read_b128 v[100:103], v73 offset:44032
    v_mfma_f32_16x16x32_bf16 v[60:63], v[124:127], v[28:31], v[60:63]
    ds_read_b128 v[104:107], v74 offset:45056
    s_waitcnt vmcnt(3)
    s_waitcnt lgkmcnt(5)
    v_mfma_f32_16x16x32_bf16 v[44:47], v[128:131], v[32:35], v[44:47]
    ds_read_b128 v[108:111], v72 offset:46080
    v_mfma_f32_16x16x32_bf16 v[48:51], v[132:135], v[32:35], v[48:51]
    ds_read_b128 v[112:115], v72 offset:47104
    v_mfma_f32_16x16x32_bf16 v[52:55], v[136:139], v[32:35], v[52:55]
    ds_read_b128 v[116:119], v73 offset:48128
    v_mfma_f32_16x16x32_bf16 v[56:59], v[140:143], v[32:35], v[56:59]
    ds_read_b128 v[120:123], v73 offset:49152
    v_mfma_f32_16x16x32_bf16 v[60:63], v[144:147], v[32:35], v[60:63]
    ds_read_b128 v[124:127], v74 offset:50176
    s_waitcnt vmcnt(2)
    s_waitcnt lgkmcnt(5)
    v_mfma_f32_16x16x32_bf16 v[44:47], v[88:91], v[4:7], v[44:47]
    ds_read_b128 v[128:131], v72 offset:51200
    v_mfma_f32_16x16x32_bf16 v[48:51], v[92:95], v[4:7], v[48:51]
    ds_read_b128 v[132:135], v72 offset:52224
    v_mfma_f32_16x16x32_bf16 v[52:55], v[96:99], v[4:7], v[52:55]
    ds_read_b128 v[136:139], v73 offset:53248
    v_mfma_f32_16x16x32_bf16 v[56:59], v[100:103], v[4:7], v[56:59]
    ds_read_b128 v[140:143], v73 offset:54272
    v_mfma_f32_16x16x32_bf16 v[60:63], v[104:107], v[4:7], v[60:63]
    ds_read_b128 v[144:147], v74 offset:55296
    s_waitcnt vmcnt(1)
    s_waitcnt lgkmcnt(5)
    v_mfma_f32_16x16x32_bf16 v[44:47], v[108:111], v[8:11], v[44:47]
    v_mfma_f32_16x16x32_bf16 v[48:51], v[112:115], v[8:11], v[48:51]
    v_mfma_f32_16x16x32_bf16 v[52:55], v[116:119], v[8:11], v[52:55]
    v_mfma_f32_16x16x32_bf16 v[56:59], v[120:123], v[8:11], v[56:59]
    v_mfma_f32_16x16x32_bf16 v[60:63], v[124:127], v[8:11], v[60:63]
    s_waitcnt vmcnt(0)
    s_waitcnt lgkmcnt(0)
    v_mfma_f32_16x16x32_bf16 v[44:47], v[128:131], v[12:15], v[44:47]
    v_mfma_f32_16x16x32_bf16 v[48:51], v[132:135], v[12:15], v[48:51]
    v_mfma_f32_16x16x32_bf16 v[52:55], v[136:139], v[12:15], v[52:55]
    v_mfma_f32_16x16x32_bf16 v[56:59], v[140:143], v[12:15], v[56:59]
    v_mfma_f32_16x16x32_bf16 v[60:63], v[144:147], v[12:15], v[60:63]
    s_nop 3
    ds_write_b128 v78, v[44:47] offset:0
    ds_write_b128 v78, v[48:51] offset:64
    ds_write_b128 v79, v[52:55] offset:128
    ds_write_b128 v79, v[56:59] offset:192
    ds_write_b128 v252, v[60:63] offset:256
    s_waitcnt lgkmcnt(0)
    s_barrier
    ds_read_b128 v[88:91], v84 offset:0
    ds_read_b128 v[92:95], v84 offset:16
    v_add_u32 v84, 81920, v84
    ds_read_b128 v[96:99], v84 offset:0
    ds_read_b128 v[100:103], v84 offset:16
    s_mov_b64 exec, 0xffff
    ds_read_b128 v[104:107], v86 offset:0
    ds_read_b128 v[108:111], v86 offset:16
    v_add_u32 v86, 81920, v86
    ds_read_b128 v[112:115], v86 offset:0
    ds_read_b128 v[116:119], v86 offset:16
    s_mov_b64 exec, -1
    s_waitcnt lgkmcnt(4)
    v_add_f32 v88, v88, v96
    v_add_f32 v89, v89, v97
    v_add_f32 v90, v90, v98
    v_add_f32 v91, v91, v99
    v_add_f32 v92, v92, v100
    v_add_f32 v93, v93, v101
    v_add_f32 v94, v94, v102
    v_add_f32 v95, v95, v103
    v_cvt_pk_bf16_f32 v88, v88, v89
    v_cvt_pk_bf16_f32 v89, v90, v91
    v_cvt_pk_bf16_f32 v90, v92, v93
    v_cvt_pk_bf16_f32 v91, v94, v95
    buffer_store_dwordx4 v[88:91], v85, s[16:19], s68 offen
    s_mov_b64 exec, 0xffff
    s_waitcnt lgkmcnt(0)
    v_add_f32 v104, v104, v112
    v_add_f32 v105, v105, v113
    v_add_f32 v106, v106, v114
    v_add_f32 v107, v107, v115
    v_add_f32 v108, v108, v116
    v_add_f32 v109, v109, v117
    v_add_f32 v110, v110, v118
    v_add_f32 v111, v111, v119
    v_cvt_pk_bf16_f32 v104, v104, v105
    v_cvt_pk_bf16_f32 v105, v106, v107
    v_cvt_pk_bf16_f32 v106, v108, v109
    v_cvt_pk_bf16_f32 v107, v110, v111
    buffer_store_dwordx4 v[104:107], v87, s[16:19], s68 offen
    s_mov_b64 exec, -1
    s_waitcnt vmcnt(0)
L_end:
    s_endpgm
.fill 216, 4, 0xbf810000
.section .rodata,"a"
.p2align 6
.amdhsa_kernel sequential_preLN__mha_block__dense_activation_silu__prompt_kernel
  .amdhsa_next_free_vgpr 256
  .amdhsa_next_free_sgpr 102
  .amdhsa_accum_offset 256
  .amdhsa_group_segment_fixed_size 0
  .amdhsa_kernarg_size 72
  .amdhsa_user_sgpr_count 2
  .amdhsa_user_sgpr_kernarg_segment_ptr 1
  .amdhsa_system_sgpr_workgroup_id_x 1
.end_amdhsa_kernel
```
